```python
import torch

def _softmax(x, axis=-1):
    return torch.softmax(x, dim=axis)

def _gelu(x):
    return torch.nn.functional.gelu(x, approximate='tanh')

def _silu(x):
    return torch.nn.functional.silu(x)

def _sigmoid(x):
    return torch.sigmoid(x)

def _layernorm(x, axis=-1, eps=1e-05):
    m = x.mean(dim=axis, keepdim=True)
    v = x.var(dim=axis, keepdim=True, unbiased=False)
    return (x - m) / torch.sqrt(v + eps)

def _scatter_add(tgt, idx, src, axis=0):
    return tgt.clone().index_add_(axis, idx, src)

def _segment_sum(src, seg, n):
    out = torch.zeros((n,) + src.shape[1:], dtype=src.dtype)
    return out.index_add_(0, seg, src)

def _pad(x, pw):
    flat = tuple((v for pair in reversed(pw) for v in pair))
    return torch.nn.functional.pad(x, flat)
kernel_name = 'standalone__tensor_product_equiv_equiformer__graph'

def setup_inputs():

    _w = lambda a: (lambda t: t.to(torch.bfloat16) if t.is_floating_point() else t)(torch.as_tensor(a))
    N, deg, C, De = (12500, 64, 64, max(4, 1))
    E = N * deg
    src = (lambda lo, hi, *s: torch.randint(lo, hi, s))(0, N, E).to(torch.int64)
    dst = (lambda lo, hi, *s: torch.randint(lo, hi, s))(0, N, E).to(torch.int64)
    rvec = (lambda *s: torch.randn(*s, dtype=torch.bfloat16) * 0.05)(E, 3).to(float)
    rn = (torch.linalg.norm(rvec, dim=-1, keepdim=True) + 1e-06).to(float)
    rhat = (rvec / rn).to(float)
    eps = torch.zeros((3, 3, 3), dtype=float)
    eps[0, 1, 2] = eps[1, 2, 0] = eps[2, 0, 1] = 1.0
    eps[0, 2, 1] = eps[2, 1, 0] = eps[1, 0, 2] = -1.0
    return {'x': _w((lambda *s: torch.randn(*s, dtype=torch.bfloat16) * 0.4)(N, 4 * C).to(float)), 'rhat': _w(rhat), 'e_attr': _w((lambda *s: torch.randn(*s, dtype=torch.bfloat16) * 0.4)(E, De).to(float)), 'src': _w(src), 'dst': _w(dst), 'w_rad': _w((lambda *s: torch.randn(*s, dtype=torch.bfloat16) * 0.4)(De, 5 * C).to(float)), 'w_si0': _w((lambda *s: torch.randn(*s, dtype=torch.bfloat16) * 0.4)(2 * C, C).to(float)), 'w_si1': _w((lambda *s: torch.randn(*s, dtype=torch.bfloat16) * 0.05)(3 * C, C).to(float)), 'cg_eps': _w(eps)}

def reference(x, rhat, e_attr, src, dst, w_rad, w_si0, w_si1, cg_eps):
    N = x.shape[0]
    C = w_si0.shape[1]
    E = rhat.shape[0]
    x0 = x[:, :C].clone()
    x1 = x[:, C:].reshape(N, 3, C)
    R = (e_attr @ w_rad).reshape(E, 5, C)
    f0 = x0[src]
    f1 = x1[src]
    Y1 = rhat
    p00_0 = f0 * R[:, 0, :]
    p11_0 = torch.einsum('ejc,ej->ec', f1, Y1) * R[:, 1, :]
    p01_1 = torch.einsum('ec,ej->ejc', f0, Y1) * R[:, 2, :][:, None, :]
    p10_1 = f1 * R[:, 3, :][:, None, :]
    p11_1 = torch.einsum('ijk,ekc,ej->eic', cg_eps, f1, Y1) * R[:, 4, :][:, None, :]
    m0 = torch.concatenate([p00_0, p11_0], axis=-1) @ w_si0
    m1 = torch.einsum('ejp,pc->ejc', torch.concatenate([p01_1, p10_1, p11_1], axis=-1), w_si1)
    agg0 = _segment_sum(m0, dst, N)
    agg1 = _segment_sum(m1.reshape(E, 3 * C), dst, N).reshape(N, 3, C)
    gate = _sigmoid(agg0)
    out1 = agg1 * gate[:, None, :]
    return torch.concatenate([agg0, out1.reshape(N, 3 * C)], axis=-1)
```

```asm
; @launch kernel=standalone__tensor_product_equiv_equiformer__graph_kernel grid=(256,1,1) block=(1024,1,1) lds=161184
.amdgcn_target "amdgcn-amd-amdhsa--gfx950"
.text
.globl standalone__tensor_product_equiv_equiformer__graph_kernel
.p2align 8
.type standalone__tensor_product_equiv_equiformer__graph_kernel,@function
standalone__tensor_product_equiv_equiformer__graph_kernel:
    s_load_dwordx8 s[4:11], s[0:1], 8
    s_cmpk_ge_u32 s2, 250
    s_cbranch_scc1 L_k1_wprep
    s_cmp_ge_u32 s2, 8
    s_cbranch_scc1 L_k1_novp
    s_getpc_b64 s[46:47]
L_k1_pc1:
    v_lshlrev_b32 v61, 7, v0
    v_cmpx_gt_u32 vcc, 128, v0
    s_cbranch_execz L_k1_vp2
    global_load_dword v127, v61, s[46:47]
L_k1_vp2:
    s_mov_b64 exec, -1
L_k1_novp:
    v_lshlrev_b32 v1, 4, v0
    v_mov_b64 v[28:29], 0
    v_mov_b64 v[30:31], 0
    s_mul_i32 s36, s2, 1600
    ds_write_b128 v1, v[28:31] offset:1024
    v_and_b32 v3, 0x3e0, v0
    v_add3_u32 v3, v3, v0, s36
    v_lshlrev_b32 v2, 3, v3
    v_lshlrev_b32 v62, 4, v3
    v_mul_u32_u24 v3, 12, v3
    v_cmpx_gt_u32 vcc, 800, v0
    s_waitcnt lgkmcnt(0)
    s_cbranch_execz L_k1_b1
    global_load_dwordx2 v[4:5], v2, s[10:11] nt
    global_load_dwordx2 v[6:7], v2, s[10:11] offset:256 nt
L_k1_b1:
    s_mov_b64 s[40:41], exec
    v_cmpx_gt_u32 vcc, 640, v0
    s_barrier
    s_cbranch_execz L_k1_a
    global_load_dwordx2 v[24:25], v2, s[8:9] nt
    global_load_dwordx3 v[16:18], v3, s[4:5] nt
    global_load_dwordx4 v[8:11], v62, s[6:7] nt
    global_load_dwordx2 v[26:27], v2, s[8:9] offset:256 nt
    global_load_dwordx3 v[20:22], v3, s[4:5] offset:384 nt
    global_load_dwordx4 v[12:15], v62, s[6:7] offset:512 nt
    s_waitcnt vmcnt(6)
    s_branch L_k1_b
L_k1_a:
    s_mov_b64 exec, s[40:41]
    s_cbranch_execz L_k1_help
    s_waitcnt vmcnt(0)
L_k1_b:
    v_mov_b32 v36, 1
    v_lshlrev_b32_sdwa v28, 2, v4 dst_sel:DWORD dst_unused:UNUSED_PAD src0_sel:DWORD src1_sel:BYTE_0
    ds_add_rtn_u32 v32, v28, v36 offset:9216
    v_lshlrev_b32_sdwa v29, 2, v5 dst_sel:DWORD dst_unused:UNUSED_PAD src0_sel:DWORD src1_sel:BYTE_0
    ds_add_rtn_u32 v33, v29, v36 offset:9216
    v_lshlrev_b32_sdwa v30, 2, v6 dst_sel:DWORD dst_unused:UNUSED_PAD src0_sel:DWORD src1_sel:BYTE_0
    ds_add_rtn_u32 v34, v30, v36 offset:9216
    v_lshlrev_b32_sdwa v31, 2, v7 dst_sel:DWORD dst_unused:UNUSED_PAD src0_sel:DWORD src1_sel:BYTE_0
    ds_add_rtn_u32 v35, v31, v36 offset:9216
    s_load_dwordx2 s[12:13], s[0:1], 88
    s_load_dwordx2 s[52:53], s[0:1], 0
    s_load_dwordx2 s[54:55], s[0:1], 72
    s_load_dwordx4 s[48:51], s[0:1], 48
    v_lshrrev_b32 v38, 6, v0
    s_and_b32 s3, s2, 7
    v_readfirstlane_b32 s16, v38
    s_lshl_b32 s3, s3, 5
    s_lshr_b32 s22, s2, 3
    s_or_b32 s3, s3, s22
    s_mov_b32 s14, 0x1200000
    s_mov_b32 s15, 0x20000
    v_mov_b32 v39, 0
    s_cmp_lt_u32 s16, 10
    s_waitcnt lgkmcnt(0)
    s_barrier
    s_cbranch_scc1 L_k1_d
    global_load_dwordx2 v[24:25], v2, s[8:9] nt
    global_load_dwordx3 v[16:18], v3, s[4:5] nt
    global_load_dwordx4 v[8:11], v62, s[6:7] nt
    global_load_dwordx2 v[26:27], v2, s[8:9] offset:256 nt
    global_load_dwordx3 v[20:22], v3, s[4:5] offset:384 nt
    global_load_dwordx4 v[12:15], v62, s[6:7] offset:512 nt
L_k1_d:
    v_lshrrev_b32 v48, 2, v32
    v_lshrrev_b32 v38, 8, v4
    v_min_u32 v48, 8, v48
    v_and_or_b32 v52, v32, 3, v28
    v_mul_u32_u24 v48, 6, v48
    v_lshlrev_b32 v52, 3, v52
    v_lshlrev_b64 v[40:41], v48, v[38:39]
    ds_or_b64 v52, v[40:41] offset:1024
    v_lshrrev_b32 v49, 2, v33
    v_lshrrev_b32 v38, 8, v5
    v_min_u32 v49, 8, v49
    v_and_or_b32 v53, v33, 3, v29
    v_mul_u32_u24 v49, 6, v49
    v_lshlrev_b32 v53, 3, v53
    v_lshlrev_b64 v[42:43], v49, v[38:39]
    ds_or_b64 v53, v[42:43] offset:1024
    v_lshrrev_b32 v50, 2, v34
    v_lshrrev_b32 v38, 8, v6
    v_min_u32 v50, 8, v50
    v_and_or_b32 v54, v34, 3, v30
    v_mul_u32_u24 v50, 6, v50
    v_lshlrev_b32 v54, 3, v54
    v_lshlrev_b64 v[40:41], v50, v[38:39]
    ds_or_b64 v54, v[40:41] offset:1024
    v_lshrrev_b32 v51, 2, v35
    v_lshrrev_b32 v38, 8, v7
    v_min_u32 v51, 8, v51
    v_and_or_b32 v55, v35, 3, v31
    v_mul_u32_u24 v51, 6, v51
    v_lshlrev_b32 v55, 3, v55
    v_lshlrev_b64 v[42:43], v51, v[38:39]
    ds_or_b64 v55, v[42:43] offset:1024
    v_max3_u32 v48, v48, v49, v50
    v_max_u32 v48, v48, v51
    v_cmp_eq_u32 vcc, 48, v48
    s_mov_b32 s46, 0x05040100
    s_mov_b32 s47, 0x05040302
    s_barrier
    ds_read_u16 v56, v28 offset:10240
    ds_read_u16 v57, v29 offset:10240
    ds_read_u16 v58, v30 offset:10240
    ds_read_u16 v59, v31 offset:10240
    s_waitcnt lgkmcnt(0)
    s_cbranch_vccnz L_k1_big
L_k1_bigdone:
    v_add_lshl_u32 v28, v56, v32, 4
    v_add_lshl_u32 v29, v57, v33, 4
    v_add_lshl_u32 v30, v58, v34, 4
    v_add_lshl_u32 v31, v59, v35, 4
    s_waitcnt vmcnt(4)
    v_alignbit_b32 v32, v18, v17, 16
    v_perm_b32 v33, v25, v18, s47
    v_perm_b32 v17, v24, v17, s46
    s_waitcnt vmcnt(3)
    ds_write2_b64 v28, v[8:9], v[16:17] offset0:0 offset1:1
    ds_write2_b64 v29, v[10:11], v[32:33] offset0:0 offset1:1
    s_waitcnt vmcnt(1)
    v_alignbit_b32 v34, v22, v21, 16
    v_perm_b32 v35, v27, v22, s47
    v_perm_b32 v21, v26, v21, s46
    s_waitcnt vmcnt(0)
    ds_write2_b64 v30, v[12:13], v[20:21] offset0:0 offset1:1
    ds_write2_b64 v31, v[14:15], v[34:35] offset0:0 offset1:1
    s_mul_i32 s36, s2, 51200
    v_add_u32 v3, 105344, v1
    s_waitcnt lgkmcnt(0)
    s_barrier
    ds_read_b128 v[4:7], v3 offset:0
    ds_read_b128 v[8:11], v3 offset:12800
    ds_read_b128 v[12:15], v3 offset:25600
    ds_read_b128 v[16:19], v3 offset:38400
    s_waitcnt lgkmcnt(3)
    buffer_store_dwordx4 v[4:7], v1, s[12:15], s36 offen sc1
    s_add_u32 s36, s36, 12800
    s_waitcnt lgkmcnt(2)
    buffer_store_dwordx4 v[8:11], v1, s[12:15], s36 offen sc1
    s_add_u32 s36, s36, 12800
    s_mov_b64 exec, -1
    v_add_u32 v52, 61440, v1
    v_mov_b64 v[40:41], 0
    v_mov_b64 v[42:43], 0
    v_mov_b32 v44, 2.0
    ds_write_b128 v52, v[40:43]
    v_mov_b32 v45, 2.0
    v_mov_b32 v46, 2.0
    v_mov_b32 v47, 2.0
    ds_write_b128 v52, v[40:43] offset:16384
    ds_write_b128 v1, v[44:47] offset:17408
    ds_write_b128 v1, v[44:47] offset:33792
    v_cmpx_gt_u32 vcc, 696, v0
    ds_write_b128 v52, v[40:43] offset:32768
    ds_write_b128 v1, v[44:47] offset:50176
    s_mov_b64 exec, -1
    s_cmp_ge_u32 s16, 2
    s_cbranch_scc1 L_noctl_1
    s_cmp_eq_u32 s16, 0
    s_cselect_b32 s22, 896, 0
    v_cmp_eq_u32 vcc, 64, v0
    v_lshlrev_b32 v52, 2, v0
    v_mul_u32_u24 v53, s22, v0
    v_mov_b32 v48, 768
    v_cndmask_b32 v53, v53, v48, vcc
    ds_write_b32 v52, v53
L_noctl_1:
    s_mov_b64 exec, s[40:41]
    s_waitcnt lgkmcnt(5)
    buffer_store_dwordx4 v[12:15], v1, s[12:15], s36 offen sc1
    s_add_u32 s36, s36, 12800
    s_waitcnt lgkmcnt(4)
    buffer_store_dwordx4 v[16:19], v1, s[12:15], s36 offen sc1
L_k1_cl:
L_k1_cl2:
    s_mov_b32 m0, 0
    s_mov_b64 exec, 1
    ds_append v61 offset:12288
    s_mov_b64 exec, -1
    s_branch L_k1_words2
L_k1_help:
    s_mov_b64 exec, -1
    s_load_dwordx2 s[12:13], s[0:1], 88
    s_load_dwordx2 s[52:53], s[0:1], 0
    s_load_dwordx2 s[54:55], s[0:1], 72
    s_load_dwordx4 s[48:51], s[0:1], 48
    v_lshrrev_b32 v38, 6, v0
    s_and_b32 s3, s2, 7
    v_readfirstlane_b32 s16, v38
    s_lshl_b32 s3, s3, 5
    s_lshr_b32 s22, s2, 3
    s_or_b32 s3, s3, s22
    s_mov_b32 s14, 0x1200000
    s_mov_b32 s15, 0x20000
    s_load_dwordx2 s[20:21], s[0:1], 40
    v_and_b32 v37, 0x3f0, v1
    s_waitcnt lgkmcnt(0)
    s_cmp_eq_u32 s16, 15
    s_cbranch_scc1 L_k1_h15
    s_barrier
    s_cmp_lg_u32 s16, 13
    s_cbranch_scc1 L_k1_nosc
    ds_read_b128 v[44:47], v37 offset:9216
    s_waitcnt lgkmcnt(0)
    v_add_u32 v49, v44, v45
    v_add_u32 v50, v49, v46
    v_add_u32 v48, v50, v47
    v_subrev_u32 v51, 6584, v48
    s_nop 1
    v_add_u32_dpp v48, v48, v48 row_shr:1 row_mask:0xf bank_mask:0xf
    s_nop 1
    v_add_u32_dpp v48, v48, v48 row_shr:2 row_mask:0xf bank_mask:0xf
    s_nop 1
    v_add_u32_dpp v48, v48, v48 row_shr:4 row_mask:0xf bank_mask:0xf
    s_nop 1
    v_add_u32_dpp v48, v48, v48 row_shr:8 row_mask:0xf bank_mask:0xf
    s_nop 1
    v_add_u32_dpp v48, v48, v48 row_bcast:15 row_mask:0xa bank_mask:0xf
    s_nop 1
    v_add_u32_dpp v48, v48, v48 row_bcast:31 row_mask:0xc bank_mask:0xf
    v_sub_u32 v52, v48, v51
    v_add_u32 v53, v52, v44
    v_add_u32 v54, v52, v49
    v_add_u32 v55, v52, v50
    v_lshl_or_b32 v44, v44, 16, v52
    v_lshl_or_b32 v45, v45, 16, v53
    v_lshl_or_b32 v46, v46, 16, v54
    v_lshl_or_b32 v47, v47, 16, v55
    ds_write_b128 v37, v[44:47] offset:10240
    s_waitcnt lgkmcnt(0)
L_k1_nosc:
    s_barrier
    s_lshl_b32 s22, s16, 8
    s_add_u32 s22, s22, s2
    s_cmp_lt_u32 s22, 3832
    s_cbranch_scc1 L_k1_noxw
    v_lshlrev_b32 v5, 3, v37
    global_load_dword v126, v5, s[48:49]
    global_load_dword v126, v5, s[50:51]
    v_add_u32 v5, 0x2000, v5
    global_load_dword v126, v5, s[48:49]
    global_load_dword v126, v5, s[50:51]
    v_add_u32 v5, 0x2000, v5
    global_load_dword v126, v5, s[50:51]
L_k1_noxw:
    v_add_u32 v52, 61440, v1
    v_mov_b64 v[40:41], 0
    v_mov_b64 v[42:43], 0
    v_mov_b32 v44, 2.0
    ds_write_b128 v52, v[40:43]
    v_mov_b32 v45, 2.0
    v_mov_b32 v46, 2.0
    v_mov_b32 v47, 2.0
    ds_write_b128 v52, v[40:43] offset:16384
    ds_write_b128 v1, v[44:47] offset:17408
    ds_write_b128 v1, v[44:47] offset:33792
    v_cmpx_gt_u32 vcc, 696, v0
    ds_write_b128 v52, v[40:43] offset:32768
    ds_write_b128 v1, v[44:47] offset:50176
    s_mov_b64 exec, -1
    s_cmp_ge_u32 s16, 2
    s_cbranch_scc1 L_noctl_2
    s_cmp_eq_u32 s16, 0
    s_cselect_b32 s22, 896, 0
    v_cmp_eq_u32 vcc, 64, v0
    v_lshlrev_b32 v52, 2, v0
    v_mul_u32_u24 v53, s22, v0
    v_mov_b32 v48, 768
    v_cndmask_b32 v53, v53, v48, vcc
    ds_write_b32 v52, v53
L_noctl_2:
    s_barrier
    s_branch L_k1_words2
L_k1_h15:
    s_mov_b32 s24, 0xd80000
    s_load_dwordx8 s[36:43], s[12:13], s24
    s_barrier
    s_barrier
L_k1_h15b:
    s_movk_i32 s22, 2560
    s_mov_b32 s23, 0x20000
    buffer_load_dwordx4 v[8:11], v37, s[20:23], 0 offen offset:0
    buffer_load_dwordx4 v[12:15], v37, s[20:23], 0 offen offset:1024
    buffer_load_dwordx4 v[16:19], v37, s[20:23], 0 offen offset:2048
    v_add_u32 v37, 157088, v37
    s_waitcnt lgkmcnt(0)
    s_add_u32 s37, s37, 0x55400000
    s_and_b32 s37, s37, 0xffc00000
    v_mov_b32 v4, s37
    s_add_u32 s39, s39, 0x2cc00000
    s_and_b32 s39, s39, 0xffc00000
    v_mov_b32 v5, s39
    s_add_u32 s41, s41, 0xba400000
    s_and_b32 s41, s41, 0xffc00000
    v_mov_b32 v6, s41
    s_add_u32 s43, s43, 0x71c00000
    s_and_b32 s43, s43, 0xffc00000
    v_mov_b32 v7, s43
    v_mov_b32 v2, 0
    ds_write_b128 v2, v[4:7] offset:512
    s_waitcnt lgkmcnt(0)
    v_add_u32 v52, 61440, v1
    v_mov_b64 v[40:41], 0
    v_mov_b64 v[42:43], 0
    v_mov_b32 v44, 2.0
    ds_write_b128 v52, v[40:43]
    v_mov_b32 v45, 2.0
    v_mov_b32 v46, 2.0
    v_mov_b32 v47, 2.0
    ds_write_b128 v52, v[40:43] offset:16384
    ds_write_b128 v1, v[44:47] offset:17408
    ds_write_b128 v1, v[44:47] offset:33792
    v_cmpx_gt_u32 vcc, 696, v0
    ds_write_b128 v52, v[40:43] offset:32768
    ds_write_b128 v1, v[44:47] offset:50176
    s_mov_b64 exec, -1
    s_cmp_ge_u32 s16, 2
    s_cbranch_scc1 L_noctl_3
    s_cmp_eq_u32 s16, 0
    s_cselect_b32 s22, 896, 0
    v_cmp_eq_u32 vcc, 64, v0
    v_lshlrev_b32 v52, 2, v0
    v_mul_u32_u24 v53, s22, v0
    v_mov_b32 v48, 768
    v_cndmask_b32 v53, v53, v48, vcc
    ds_write_b32 v52, v53
L_noctl_3:
    s_barrier
    s_waitcnt vmcnt(0)
    ds_write_b128 v37, v[8:11] offset:0
    ds_write_b128 v37, v[12:15] offset:1024
    ds_write_b128 v37, v[16:19] offset:2048
    s_branch L_k1_words2
L_k1_wprep:
    s_cmpk_ge_u32 s2, 256
    s_waitcnt lgkmcnt(0)
    s_cbranch_scc1 L_k2_end
    s_load_dwordx2 s[12:13], s[0:1], 88
    s_load_dwordx2 s[52:53], s[0:1], 0
    s_load_dwordx2 s[54:55], s[0:1], 72
    s_load_dwordx4 s[48:51], s[0:1], 48
    v_lshrrev_b32 v38, 6, v0
    s_and_b32 s3, s2, 7
    v_readfirstlane_b32 s16, v38
    s_lshl_b32 s3, s3, 5
    s_lshr_b32 s22, s2, 3
    s_or_b32 s3, s3, s22
    s_mov_b32 s14, 0x1200000
    s_mov_b32 s15, 0x20000
    s_load_dwordx2 s[20:21], s[0:1], 40
    v_lshlrev_b32 v1, 4, v0
    v_and_b32 v37, 0x3f0, v1
    v_mov_b64 v[28:29], 0
    v_mov_b64 v[30:31], 0
    ds_write_b128 v1, v[28:31] offset:1024
    s_waitcnt lgkmcnt(0)
    s_cmp_lg_u32 s16, 15
    s_cbranch_scc1 L_k1_w0
    s_mov_b32 s24, 0xd80000
    s_load_dwordx8 s[36:43], s[12:13], s24
    s_branch L_k1_h15b
L_k1_w0:
    s_cmp_lg_u32 s16, 0
    s_cbranch_scc1 L_k1_wend
    v_lshlrev_b32 v5, 3, v37
    global_load_dword v126, v5, s[48:49]
    global_load_dword v126, v5, s[50:51]
    v_add_u32 v5, 0x2000, v5
    global_load_dword v126, v5, s[48:49]
    global_load_dword v126, v5, s[50:51]
    v_add_u32 v5, 0x2000, v5
    global_load_dword v126, v5, s[50:51]
L_k1_wend:
    s_barrier
L_k1_words:
    v_add_u32 v52, 61440, v1
    v_mov_b64 v[40:41], 0
    v_mov_b64 v[42:43], 0
    v_mov_b32 v44, 2.0
    ds_write_b128 v52, v[40:43]
    v_mov_b32 v45, 2.0
    v_mov_b32 v46, 2.0
    v_mov_b32 v47, 2.0
    ds_write_b128 v52, v[40:43] offset:16384
    ds_write_b128 v1, v[44:47] offset:17408
    ds_write_b128 v1, v[44:47] offset:33792
    v_cmpx_gt_u32 vcc, 696, v0
    ds_write_b128 v52, v[40:43] offset:32768
    ds_write_b128 v1, v[44:47] offset:50176
    s_mov_b64 exec, -1
    s_cmp_ge_u32 s16, 2
    s_cbranch_scc1 L_noctl_4
    s_cmp_eq_u32 s16, 0
    s_cselect_b32 s22, 896, 0
    v_cmp_eq_u32 vcc, 64, v0
    v_lshlrev_b32 v52, 2, v0
    v_mul_u32_u24 v53, s22, v0
    v_mov_b32 v48, 768
    v_cndmask_b32 v53, v53, v48, vcc
    ds_write_b32 v52, v53
L_noctl_4:
L_k1_words2:
    v_lshlrev_b32 v2, 1, v0
    v_and_b32 v3, 1, v0
    ds_read_b128 v[28:31], v1 offset:1024
    ds_read_u16 v32, v2 offset:10240
    v_lshlrev_b32 v2, 3, v3
    ds_read_b64 v[34:35], v2 offset:512
    v_and_b32 v2, 3, v0
    v_lshlrev_b32 v2, 2, v2
    ds_read_b32 v18, v2 offset:512
    v_mul_u32_u24 v3, 6584, v3
    v_subrev_u32 v3, 6584, v3
    s_mov_b32 s46, 0xffff
    s_waitcnt lgkmcnt(0)
    v_add_u32 v32, v32, v3
    v_and_b32 v33, 63, v32
    v_bfe_u32 v32, v32, 6, 6
    v_lshl_or_b32 v34, v33, 16, v34
    v_lshl_or_b32 v35, v32, 16, v35
    v_bfi_b32 v29, s46, v29, v34
    v_bfi_b32 v31, s46, v31, v35
L_k1_drain:
    s_mov_b32 s4, s52
    s_mov_b32 s5, s53
    s_mov_b32 s6, 0x61a800
    s_mov_b32 s7, 0x20000
    s_mov_b32 s8, s54
    s_mov_b32 s9, s55
    s_mov_b32 s10, 0x61a800
    s_mov_b32 s11, 0x20000
    s_mov_b32 s17, 0
    s_mov_b32 s20, 0
    s_mov_b32 s28, 1
    s_movk_i32 s21, 111
    s_mov_b32 s26, 0x05040100
    s_mov_b32 s27, 0x07060302
    v_mov_b32 v98, v1
    v_mov_b32 v19, 2
    v_lshrrev_b32 v4, 2, v0
    v_and_b32 v15, 3, v0
    v_lshlrev_b32 v5, 13, v4
    v_lshl_add_u32 v5, v15, 3, v5
    s_lshl_b32 s25, s3, 5
    s_add_u32 s25, s25, 0x1000000
    s_cmp_ge_u32 s16, 8
    s_mov_b32 s22, 0x4c132220
    s_cselect_b32 s22, 0x14c3c143, s22
    s_and_b32 s23, s16, 7
    s_lshl_b32 s23, s23, 1
    s_add_u32 s23, s23, 157088
    v_bfe_u32 v100, v0, 3, 1
    v_bfe_u32 v101, v0, 4, 2
    v_lshl_add_u32 v100, v100, 2, v101
    v_lshlrev_b32 v100, 2, v100
    v_lshrrev_b32 v101, v100, s22
    v_and_b32 v100, 7, v101
    v_lshlrev_b32 v101, 28, v101
    v_and_b32 v101, 0x80000000, v101
    v_and_b32 v102, 0x70, v1
    v_lshl_add_u32 v100, v100, 7, v102
    v_add_u32 v100, s23, v100
    v_mov_b64 v[104:105], 0
    v_mov_b64 v[106:107], 0
    v_and_b32 v99, 63, v0
    s_sub_u32 s22, s16, 8
    s_cmp_lt_u32 s22, 4
    s_cselect_b32 s58, 33554431, 0
    s_cselect_b32 s59, 0, 0
    s_mul_i32 s22, s22, 25
    v_add_lshl_u32 v99, v99, s22, 7
    v_and_b32 v102, 0xffffff00, v99
    s_mul_i32 s22, s2, 25088
    v_add3_u32 v99, v99, v102, s22
    v_mul_u32_u24 v4, 3200, v4
    v_lshlrev_b32 v6, 3, v15
    s_mov_b32 s23, 0x16100600
    v_bfe_u32 v6, s23, v6, 8
    v_add_u32 v15, s17, v15
    v_add_u32 v4, v4, v15
    s_movk_i32 s23, 0xfc
    v_bfe_u32 v9, v0, 4, 2
    v_bfe_u32 v10, v0, 2, 2
    v_and_b32 v11, 3, v0
    v_lshlrev_b32 v27, 4, v0
    v_and_b32 v1, 0xf0, v27
    v_and_b32 v27, 0x3f0, v27
    v_cmp_eq_u32 vcc, 3, v10
    v_add_u32 v11, 2176, v11
    v_mul_u32_u24 v2, 0xe000e0, v9
    v_addc_co_u32 v11, vcc, v11, v11, vcc
    v_lshl_add_u32 v2, v10, 3, v2
    s_sub_u32 s22, 48, s16
    s_mul_i32 s22, s22, 896
    v_lshl_add_u32 v2, v11, 18, v2
    v_sub_u32 v8, 48, v0
    v_add_u32_sdwa v3, s22, v2 dst_sel:DWORD dst_unused:UNUSED_PAD src0_sel:DWORD src1_sel:WORD_1
    v_and_b32 v8, 63, v8
    s_movk_i32 s22, 896
    v_lshlrev_b32 v24, 2, v8
    v_mad_u32_u24 v25, v8, s22, -6
    v_mul_u32_u24 v26, 0xe0001, v8
    v_lshl_add_u32 v26, v26, 6, 40
    v_lshlrev_b32 v10, 3, v10
    s_mov_b32 s38, 0x0c0e0c08
    v_bfe_u32 v22, s38, v10, 8
    v_mov_b32 v23, 0
    v_mul_u32_u24 v22, 0x101, v22
    s_movk_i32 s38, 0x3f80
    v_or_b32 v22, 0x100, v22
    v_lshlrev_b64 v[22:23], v1, v[22:23]
    v_xor_b32 v22, 0x0c0c0c0c, v22
    v_xor_b32 v23, 0x0c0c0c0c, v23
    s_mov_b32 m0, 0
    s_mov_b32 s29, 0x400008
    s_movk_i32 s30, 3136
    s_mov_b32 s19, 0
    s_mov_b32 s36, -1
    s_lshl_b32 s24, s2, 13
    s_add_u32 s24, s24, 0x1000000
    s_cmp_ge_u32 s16, 10
    s_cbranch_scc1 L_nows_5
    s_cmpk_ge_u32 s2, 250
    s_cselect_b32 s40, 0, 13
    v_mov_b32 v60, 0
L_k2_wsp:
    ds_read_b32 v61, v60 offset:12288
    s_waitcnt lgkmcnt(0)
    v_cmp_gt_u32 vcc, s40, v61
    s_cbranch_vccnz L_k2_wsp
    s_cmp_ge_u32 s16, 4
    s_cselect_b32 s48, s50, s48
    s_cselect_b32 s49, s51, s49
    s_cselect_b32 s22, 4*4096, 0
    s_mul_i32 s40, s16, 3072
    s_sub_u32 s22, s40, s22
    s_lshl_b32 s40, s16, 10
    s_add_u32 m0, s40, 105344
    v_add_u32 v60, s22, v98
    global_load_lds_dwordx4 v60, s[48:49] offset:0
    s_add_u32 m0, m0, 11776
    s_nop 0
    global_load_lds_dwordx4 v60, s[48:49] offset:1024
    s_add_u32 m0, m0, 11776
    s_nop 0
    global_load_lds_dwordx4 v60, s[48:49] offset:2048
    s_add_u32 m0, m0, 11776
    s_nop 0
    global_load_lds_dwordx4 v60, s[48:49] offset:3072
    s_mov_b32 m0, 0
    s_cmp_ge_u32 s16, 8
    s_waitcnt vmcnt(4)
    s_branch L_k2_we4
L_nows_5:
    s_cmp_ge_u32 s16, 8
    s_waitcnt vmcnt(0) lgkmcnt(0)
L_k2_we4:
    s_barrier
    s_cbranch_scc1 L_k2_nopub
    buffer_store_dwordx4 v[28:31], v98, s[12:15], s24 offen sc1
L_k2_nopub:
    ds_read_u16_d16_hi v104, v100 offset:0
    ds_read_u16_d16_hi v105, v100 offset:640
    ds_read_u16_d16_hi v106, v100 offset:1280
    ds_read_u16_d16_hi v107, v100 offset:1920
    s_mov_b64 exec, s[58:59]
    buffer_load_dword v127, v99, s[4:7], 0 offen
    s_mov_b64 exec, -1
    s_waitcnt lgkmcnt(0)
    v_xor_b32 v104, v101, v104
    v_xor_b32 v105, v101, v105
    v_xor_b32 v106, v101, v106
    v_xor_b32 v107, v101, v107
    ds_write_b128 v98, v[104:107] offset:1024
    s_mov_b32 s24, 0x40000
    s_mov_b32 s22, 0x400000
    s_cmpk_ge_u32 s2, 250
    s_cbranch_scc1 L_k2_pre
L_k2_preok:
    s_waitcnt vmcnt(0)
L_k2_noack:
    s_barrier
    s_branch L_k2_pld
L_k2_poll:
    s_sleep 1
L_k2_pld:
    buffer_load_dwordx2 v[16:17], v5, s[12:15], s25 offen sc1
L_k2_plw:
    s_sub_u32 s24, s24, 1
    s_waitcnt vmcnt(0)
    s_cbranch_scc1 L_k2_giveup
L_k2_pck:
    v_xor_b32 v7, v17, v18
    v_cmp_le_u32 vcc, s22, v7
    s_wqm_b64 exec, vcc
    s_cbranch_scc1 L_k2_poll
L_k2_ent:
    s_mov_b64 exec, -1
    v_bfe_u32 v5, v17, 16, 6
    v_lshlrev_b32 v6, v6, v5
    s_mov_b32 s22, 1900544
    s_nop 0
    v_or_b32_dpp v6, v6, v6 quad_perm:[1,0,3,2] row_mask:0xf bank_mask:0xf
    s_nop 1
    v_or_b32_dpp v6, v6, v6 quad_perm:[2,3,0,1] row_mask:0xf bank_mask:0xf
    v_add_u32_sdwa v4, v4, v6 dst_sel:DWORD dst_unused:UNUSED_PAD src0_sel:DWORD src1_sel:WORD_0
    v_cmp_gt_u32 vcc, s22, v6
    v_and_b32 v7, 3, v4
    v_sub_u32_sdwa v5, v6, v15 dst_sel:DWORD dst_unused:UNUSED_PAD src0_sel:WORD_1 src1_sel:DWORD
    v_cndmask_b32 v8, 0, v15, vcc
    v_lshlrev_b32 v4, 4, v4
    v_cmpx_lt_u32 vcc, v7, v8
    v_subrev_u32 v4, 64, v4
    v_add_u32 v5, 4, v5
    v_lshlrev_b64 v[16:17], 6, v[16:17]
    s_not_b64 exec, vcc
    v_cmpx_lt_i32 s[40:41], 0, v5
    v_lshlrev_b32 v7, 2, v16
    s_cbranch_execz L_k2_few
    buffer_load_dwordx4 v[28:31], v4, s[12:15], 0 offen offset:0 sc1
    v_and_b32 v7, s23, v7
    ds_add_rtn_u32 v7, v7, v19 offset:0
    s_mov_b64 exec, -1
    v_cmpx_lt_i32 s[42:43], 4, v5
    v_lshrrev_b32 v8, 4, v16
    s_cbranch_execz L_k2_few
    buffer_load_dwordx4 v[32:35], v4, s[12:15], 0 offen offset:64 sc1
    v_and_b32 v8, s23, v8
    ds_add_rtn_u32 v8, v8, v19 offset:0
    v_cmpx_lt_i32 s[44:45], 8, v5
    v_lshrrev_b32 v9, 10, v16
    s_cbranch_execz L_k2_few
    buffer_load_dwordx4 v[36:39], v4, s[12:15], 0 offen offset:128 sc1
    v_and_b32 v9, s23, v9
    ds_add_rtn_u32 v9, v9, v19 offset:0
    v_cmpx_lt_i32 s[46:47], 12, v5
    v_lshrrev_b32 v10, 16, v16
    s_cbranch_execz L_k2_few
    buffer_load_dwordx4 v[40:43], v4, s[12:15], 0 offen offset:192 sc1
    v_and_b32 v10, s23, v10
    ds_add_rtn_u32 v10, v10, v19 offset:0
    v_cmpx_lt_i32 s[48:49], 16, v5
    v_lshrrev_b32 v11, 22, v16
    s_cbranch_execz L_k2_few
    buffer_load_dwordx4 v[44:47], v4, s[12:15], 0 offen offset:256 sc1
    v_and_b32 v11, s23, v11
    ds_add_rtn_u32 v11, v11, v19 offset:0
    v_cmpx_lt_i32 s[50:51], 20, v5
    v_alignbit_b32 v12, v17, v16, 28
    s_cbranch_execz L_k2_cnt
    buffer_load_dwordx4 v[48:51], v4, s[12:15], 0 offen offset:320 sc1
    v_and_b32 v12, s23, v12
    ds_add_rtn_u32 v12, v12, v19 offset:0
    v_cmpx_lt_i32 s[52:53], 24, v5
    v_lshrrev_b32 v13, 2, v17
    s_cbranch_execz L_k2_cnt
    buffer_load_dwordx4 v[52:55], v4, s[12:15], 0 offen offset:384 sc1
    v_and_b32 v13, s23, v13
    ds_add_rtn_u32 v13, v13, v19 offset:0
    v_cmpx_lt_i32 s[54:55], 28, v5
    v_lshrrev_b32 v14, 8, v17
    s_cbranch_execz L_k2_cnt
    buffer_load_dwordx4 v[56:59], v4, s[12:15], 0 offen offset:448 sc1
    v_and_b32 v14, s23, v14
    ds_add_rtn_u32 v14, v14, v19 offset:0
    v_cmpx_lt_i32 s[56:57], 32, v5
    s_cbranch_execz L_k2_cnt
    s_branch L_k2_nine
L_k2_few:
    s_waitcnt vmcnt(0)
L_k2_cnt:
    s_waitcnt lgkmcnt(0)
    s_mov_b64 exec, s[40:41]
    s_cbranch_execz L_k2_placed
    v_and_b32 v4, 6, v7
    v_mad_u32_u24 v7, v4, s21, v7
    s_waitcnt vmcnt(4)
    ds_write_b64 v7, v[30:31] offset:17408
    ds_write_b64 v7, v[28:29] offset:61440
    s_mov_b64 exec, s[42:43]
    s_cbranch_execz L_k2_placed
    v_and_b32 v4, 6, v8
    v_mad_u32_u24 v8, v4, s21, v8
    s_waitcnt vmcnt(3)
    ds_write_b64 v8, v[34:35] offset:17408
    ds_write_b64 v8, v[32:33] offset:61440
    s_mov_b64 exec, s[44:45]
    s_cbranch_execz L_k2_placed
    v_and_b32 v4, 6, v9
    v_mad_u32_u24 v9, v4, s21, v9
    s_waitcnt vmcnt(2)
    ds_write_b64 v9, v[38:39] offset:17408
    ds_write_b64 v9, v[36:37] offset:61440
    s_mov_b64 exec, s[46:47]
    s_cbranch_execz L_k2_placed
    v_and_b32 v4, 6, v10
    v_mad_u32_u24 v10, v4, s21, v10
    s_waitcnt vmcnt(1)
    ds_write_b64 v10, v[42:43] offset:17408
    ds_write_b64 v10, v[40:41] offset:61440
    s_mov_b64 exec, s[48:49]
    s_cbranch_execz L_k2_placed
    v_and_b32 v4, 6, v11
    v_mad_u32_u24 v11, v4, s21, v11
    s_waitcnt vmcnt(0)
    ds_write_b64 v11, v[46:47] offset:17408
    ds_write_b64 v11, v[44:45] offset:61440
    s_mov_b64 exec, s[50:51]
    s_cbranch_execz L_k2_placed
    v_and_b32 v4, 6, v12
    v_mad_u32_u24 v12, v4, s21, v12
    ds_write_b64 v12, v[50:51] offset:17408
    ds_write_b64 v12, v[48:49] offset:61440
    s_mov_b64 exec, s[52:53]
    s_cbranch_execz L_k2_placed
    v_and_b32 v4, 6, v13
    v_mad_u32_u24 v13, v4, s21, v13
    ds_write_b64 v13, v[54:55] offset:17408
    ds_write_b64 v13, v[52:53] offset:61440
    s_mov_b64 exec, s[54:55]
    s_cbranch_execz L_k2_placed
    v_and_b32 v4, 6, v14
    v_mad_u32_u24 v14, v4, s21, v14
    ds_write_b64 v14, v[58:59] offset:17408
    ds_write_b64 v14, v[56:57] offset:61440
    s_mov_b64 exec, s[56:57]
    s_cbranch_execz L_k2_placed
    v_and_b32 v4, 6, v15
    v_mad_u32_u24 v15, v4, s21, v15
    ds_write_b64 v15, v[62:63] offset:17408
    ds_write_b64 v15, v[60:61] offset:61440
L_k2_placed:
    s_mov_b64 exec, s[58:59]
    s_mov_b32 s22, 100352
    buffer_load_dword v127, v99, s[4:7], s22 offen
L_k2_nt2:
    s_mov_b64 exec, -1
L_k2_fin:
    s_cmp_ge_u32 s16, 12
    s_waitcnt lgkmcnt(0)
    s_barrier
    s_cbranch_scc1 L_k2_cw
    ds_read2_b32 v[20:21], v3 offset1:8
    ds_read_b32 v13, v24 offset:0
    s_waitcnt lgkmcnt(1)
    v_lshlrev_b32_sdwa v4, 9, v20 dst_sel:DWORD dst_unused:UNUSED_PAD src0_sel:DWORD src1_sel:WORD_1
    v_lshlrev_b32_sdwa v5, 9, v21 dst_sel:DWORD dst_unused:UNUSED_PAD src0_sel:DWORD src1_sel:WORD_1
    v_mov_b32 v7, v27
    v_add_u32_dpp v107, v4, v1 row_newbcast:12 row_mask:0xf bank_mask:0xf
    buffer_load_dwordx4 v[64:67], v107, s[4:7], 0 offen
    v_add_u32_dpp v111, v4, v1 row_newbcast:13 row_mask:0xf bank_mask:0xf
    buffer_load_dwordx4 v[68:71], v111, s[4:7], 0 offen
    v_add_u32_dpp v115, v4, v1 row_newbcast:14 row_mask:0xf bank_mask:0xf
    buffer_load_dwordx4 v[72:75], v115, s[4:7], 0 offen
    v_add_u32_dpp v119, v4, v1 row_newbcast:15 row_mask:0xf bank_mask:0xf
    buffer_load_dwordx4 v[76:79], v119, s[4:7], 0 offen
    v_add_u32_dpp v123, v5, v1 row_newbcast:12 row_mask:0xf bank_mask:0xf
    buffer_load_dwordx4 v[80:83], v123, s[4:7], 0 offen
    v_add_u32_dpp v127, v5, v1 row_newbcast:13 row_mask:0xf bank_mask:0xf
    buffer_load_dwordx4 v[84:87], v127, s[4:7], 0 offen
    v_add_u32_dpp v4, v5, v1 row_newbcast:14 row_mask:0xf bank_mask:0xf
    buffer_load_dwordx4 v[88:91], v4, s[4:7], 0 offen
    v_add_u32_dpp v5, v5, v1 row_newbcast:15 row_mask:0xf bank_mask:0xf
    buffer_load_dwordx4 v[92:95], v5, s[4:7], 0 offen
L_k2_cw1:
    s_waitcnt lgkmcnt(0)
    v_sub_u32 v13, v13, v25
    v_cmp_lt_u32 vcc, 230, v13
    v_lshrrev_b32 v13, 3, v13
    v_add_u32 v6, 105344, v27
    v_readlane_b32 s18, v13, 49
    s_cbranch_vccnz L_k2_over
L_k2_go:
    v_max_u32 v13, 9, v13
    s_cbranch_scc1 L_k2_spec
    v_sub_u32 v3, v26, v13
    ds_read_b128 v[24:27], v7 offset:1024
    ds_read_b128 v[12:15], v7 offset:2048
    ds_read_b128 v[16:19], v7 offset:3072
    ds_read_b128 v[8:11], v7 offset:4096
    v_readlane_b32 s33, v3, s16
    s_setprio 2
    s_add_u32 s33, s33, s29
    s_bitcmp1_b32 s33, 5
    s_cbranch_scc0 L_gd_7
    ds_append v0 offset:256
L_gd_7:
    v_add_u32_sdwa v4, s33, v2 dst_sel:DWORD dst_unused:UNUSED_PAD src0_sel:WORD_1 src1_sel:WORD_0
    ds_read_b64_tr_b16 v[98:99], v4 offset:61376
    v_perm_b32 v96, s38, v20, v22
    v_perm_b32 v97, s38, v20, v23
    ds_read_b64_tr_b16 v[102:103], v4 offset:61408
    v_perm_b32 v100, s38, v21, v22
    v_perm_b32 v101, s38, v21, v23
    v_add_u32_sdwa v21, s33, v2 dst_sel:DWORD dst_unused:UNUSED_PAD src0_sel:WORD_1 src1_sel:WORD_1
    ds_read2_b32 v[20:21], v21 offset1:8
    s_waitcnt lgkmcnt(0)
    v_mfma_f32_4x4x4_16b_bf16 v[96:99], v[96:97], v[98:99], 0
    v_mfma_f32_4x4x4_16b_bf16 v[100:103], v[100:101], v[102:103], 0
    v_lshlrev_b32_sdwa v4, 9, v20 dst_sel:DWORD dst_unused:UNUSED_PAD src0_sel:DWORD src1_sel:WORD_1
    v_lshlrev_b32_sdwa v5, 9, v21 dst_sel:DWORD dst_unused:UNUSED_PAD src0_sel:DWORD src1_sel:WORD_1
    s_nop 1
    v_cvt_pk_bf16_f32 v28, v96, v97
    v_cvt_pk_bf16_f32 v29, v98, v99
    v_cvt_pk_bf16_f32 v30, v100, v101
    v_cvt_pk_bf16_f32 v31, v102, v103
    s_branch L_k2_first
L_k2_partf:
    v_readfirstlane_b32 s22, v0
    s_mov_b32 s32, s33
    s_cmp_ge_u32 s22, s30
    s_cbranch_scc1 L_gr_8
L_gb_9:
    s_lshr_b32 s22, s22, 6
    v_readlane_b32 s33, v3, s22
L_gd_10:
    s_bitcmp0_b32 s32, 1
    s_cbranch_scc1 L_k2_tf1
    s_bitcmp0_b32 s32, 0
    s_cbranch_scc1 L_k2_tf2
    v_add_u32_dpp v107, v4, v1 row_newbcast:12 row_mask:0xf bank_mask:0xf
    v_add_u32_dpp v111, v4, v1 row_newbcast:13 row_mask:0xf bank_mask:0xf
    v_add_u32_dpp v115, v4, v1 row_newbcast:14 row_mask:0xf bank_mask:0xf
    v_add_u32_dpp v119, v4, v1 row_newbcast:15 row_mask:0xf bank_mask:0xf
    v_add_u32_dpp v123, v5, v1 row_newbcast:12 row_mask:0xf bank_mask:0xf
    s_waitcnt vmcnt(0)
    v_perm_b32 v96, v68, v64, s26
    v_perm_b32 v100, v68, v64, s27
    v_perm_b32 v104, v69, v65, s26
    v_perm_b32 v108, v69, v65, s27
    v_perm_b32 v112, v70, v66, s26
    v_perm_b32 v116, v70, v66, s27
    v_perm_b32 v120, v71, v67, s26
    v_perm_b32 v124, v71, v67, s27
    buffer_load_dwordx4 v[64:67], v107, s[4:7], 0 offen
    buffer_load_dwordx4 v[68:71], v111, s[4:7], 0 offen
    v_perm_b32 v97, v76, v72, s26
    v_perm_b32 v101, v76, v72, s27
    v_perm_b32 v105, v77, v73, s26
    v_perm_b32 v109, v77, v73, s27
    v_perm_b32 v113, v78, v74, s26
    v_perm_b32 v117, v78, v74, s27
    v_perm_b32 v121, v79, v75, s26
    v_perm_b32 v125, v79, v75, s27
    buffer_load_dwordx4 v[72:75], v115, s[4:7], 0 offen
    buffer_load_dwordx4 v[76:79], v119, s[4:7], 0 offen
    v_perm_b32 v98, v84, v80, s26
    v_perm_b32 v102, v84, v80, s27
    v_perm_b32 v106, v85, v81, s26
    v_perm_b32 v110, v85, v81, s27
    v_perm_b32 v114, v86, v82, s26
    v_perm_b32 v118, v86, v82, s27
    v_perm_b32 v122, v87, v83, s26
    v_perm_b32 v126, v87, v83, s27
    buffer_load_dwordx4 v[80:83], v123, s[4:7], 0 offen
    v_perm_b32 v99, v92, v88, s26
    v_perm_b32 v103, v92, v88, s27
    v_perm_b32 v107, v93, v89, s26
    v_perm_b32 v111, v93, v89, s27
    v_perm_b32 v115, v94, v90, s26
    v_perm_b32 v119, v94, v90, s27
    v_perm_b32 v123, v95, v91, s26
    v_perm_b32 v127, v95, v91, s27
    s_branch L_k2_backp
L_k2_tf2:
    v_add_u32_dpp v107, v4, v1 row_newbcast:12 row_mask:0xf bank_mask:0xf
    v_add_u32_dpp v111, v4, v1 row_newbcast:13 row_mask:0xf bank_mask:0xf
    v_add_u32_dpp v115, v4, v1 row_newbcast:14 row_mask:0xf bank_mask:0xf
    v_add_u32_dpp v119, v4, v1 row_newbcast:15 row_mask:0xf bank_mask:0xf
    v_add_u32_dpp v123, v5, v1 row_newbcast:12 row_mask:0xf bank_mask:0xf
    v_add_u32_dpp v127, v5, v1 row_newbcast:13 row_mask:0xf bank_mask:0xf
    s_waitcnt vmcnt(0)
    v_perm_b32 v96, v68, v64, s26
    v_perm_b32 v100, v68, v64, s27
    v_perm_b32 v104, v69, v65, s26
    v_perm_b32 v108, v69, v65, s27
    v_perm_b32 v112, v70, v66, s26
    v_perm_b32 v116, v70, v66, s27
    v_perm_b32 v120, v71, v67, s26
    v_perm_b32 v124, v71, v67, s27
    buffer_load_dwordx4 v[64:67], v107, s[4:7], 0 offen
    buffer_load_dwordx4 v[68:71], v111, s[4:7], 0 offen
    v_perm_b32 v97, v76, v72, s26
    v_perm_b32 v101, v76, v72, s27
    v_perm_b32 v105, v77, v73, s26
    v_perm_b32 v109, v77, v73, s27
    v_perm_b32 v113, v78, v74, s26
    v_perm_b32 v117, v78, v74, s27
    v_perm_b32 v121, v79, v75, s26
    v_perm_b32 v125, v79, v75, s27
    buffer_load_dwordx4 v[72:75], v115, s[4:7], 0 offen
    buffer_load_dwordx4 v[76:79], v119, s[4:7], 0 offen
    v_perm_b32 v98, v84, v80, s26
    v_perm_b32 v102, v84, v80, s27
    v_perm_b32 v106, v85, v81, s26
    v_perm_b32 v110, v85, v81, s27
    v_perm_b32 v114, v86, v82, s26
    v_perm_b32 v118, v86, v82, s27
    v_perm_b32 v122, v87, v83, s26
    v_perm_b32 v126, v87, v83, s27
    buffer_load_dwordx4 v[80:83], v123, s[4:7], 0 offen
    buffer_load_dwordx4 v[84:87], v127, s[4:7], 0 offen
    v_perm_b32 v99, v92, v88, s26
    v_perm_b32 v103, v92, v88, s27
    v_perm_b32 v107, v93, v89, s26
    v_perm_b32 v111, v93, v89, s27
    v_perm_b32 v115, v94, v90, s26
    v_perm_b32 v119, v94, v90, s27
    v_perm_b32 v123, v95, v91, s26
    v_perm_b32 v127, v95, v91, s27
    s_branch L_k2_backp
L_k2_tf1:
    s_bitcmp0_b32 s32, 0
    s_cbranch_scc1 L_k2_tf0
    v_add_u32_dpp v107, v4, v1 row_newbcast:12 row_mask:0xf bank_mask:0xf
    v_add_u32_dpp v111, v4, v1 row_newbcast:13 row_mask:0xf bank_mask:0xf
    v_add_u32_dpp v115, v4, v1 row_newbcast:14 row_mask:0xf bank_mask:0xf
    v_add_u32_dpp v119, v4, v1 row_newbcast:15 row_mask:0xf bank_mask:0xf
    v_add_u32_dpp v123, v5, v1 row_newbcast:12 row_mask:0xf bank_mask:0xf
    v_add_u32_dpp v127, v5, v1 row_newbcast:13 row_mask:0xf bank_mask:0xf
    v_add_u32_dpp v4, v5, v1 row_newbcast:14 row_mask:0xf bank_mask:0xf
    s_waitcnt vmcnt(0)
    v_perm_b32 v96, v68, v64, s26
    v_perm_b32 v100, v68, v64, s27
    v_perm_b32 v104, v69, v65, s26
    v_perm_b32 v108, v69, v65, s27
    v_perm_b32 v112, v70, v66, s26
    v_perm_b32 v116, v70, v66, s27
    v_perm_b32 v120, v71, v67, s26
    v_perm_b32 v124, v71, v67, s27
    buffer_load_dwordx4 v[64:67], v107, s[4:7], 0 offen
    buffer_load_dwordx4 v[68:71], v111, s[4:7], 0 offen
    v_perm_b32 v97, v76, v72, s26
    v_perm_b32 v101, v76, v72, s27
    v_perm_b32 v105, v77, v73, s26
    v_perm_b32 v109, v77, v73, s27
    v_perm_b32 v113, v78, v74, s26
    v_perm_b32 v117, v78, v74, s27
    v_perm_b32 v121, v79, v75, s26
    v_perm_b32 v125, v79, v75, s27
    buffer_load_dwordx4 v[72:75], v115, s[4:7], 0 offen
    buffer_load_dwordx4 v[76:79], v119, s[4:7], 0 offen
    v_perm_b32 v98, v84, v80, s26
    v_perm_b32 v102, v84, v80, s27
    v_perm_b32 v106, v85, v81, s26
    v_perm_b32 v110, v85, v81, s27
    v_perm_b32 v114, v86, v82, s26
    v_perm_b32 v118, v86, v82, s27
    v_perm_b32 v122, v87, v83, s26
    v_perm_b32 v126, v87, v83, s27
    buffer_load_dwordx4 v[80:83], v123, s[4:7], 0 offen
    buffer_load_dwordx4 v[84:87], v127, s[4:7], 0 offen
    v_perm_b32 v99, v92, v88, s26
    v_perm_b32 v103, v92, v88, s27
    v_perm_b32 v107, v93, v89, s26
    v_perm_b32 v111, v93, v89, s27
    v_perm_b32 v115, v94, v90, s26
    v_perm_b32 v119, v94, v90, s27
    v_perm_b32 v123, v95, v91, s26
    v_perm_b32 v127, v95, v91, s27
    buffer_load_dwordx4 v[88:91], v4, s[4:7], 0 offen
    s_branch L_k2_backp
L_k2_tf0:
    v_add_u32_dpp v107, v4, v1 row_newbcast:12 row_mask:0xf bank_mask:0xf
    v_add_u32_dpp v111, v4, v1 row_newbcast:13 row_mask:0xf bank_mask:0xf
    v_add_u32_dpp v115, v4, v1 row_newbcast:14 row_mask:0xf bank_mask:0xf
    v_add_u32_dpp v119, v4, v1 row_newbcast:15 row_mask:0xf bank_mask:0xf
    v_add_u32_dpp v123, v5, v1 row_newbcast:12 row_mask:0xf bank_mask:0xf
    v_add_u32_dpp v127, v5, v1 row_newbcast:13 row_mask:0xf bank_mask:0xf
    v_add_u32_dpp v4, v5, v1 row_newbcast:14 row_mask:0xf bank_mask:0xf
    v_add_u32_dpp v5, v5, v1 row_newbcast:15 row_mask:0xf bank_mask:0xf
    s_waitcnt vmcnt(0)
    v_perm_b32 v96, v68, v64, s26
    v_perm_b32 v100, v68, v64, s27
    v_perm_b32 v104, v69, v65, s26
    v_perm_b32 v108, v69, v65, s27
    v_perm_b32 v112, v70, v66, s26
    v_perm_b32 v116, v70, v66, s27
    v_perm_b32 v120, v71, v67, s26
    v_perm_b32 v124, v71, v67, s27
    buffer_load_dwordx4 v[64:67], v107, s[4:7], 0 offen
    buffer_load_dwordx4 v[68:71], v111, s[4:7], 0 offen
    v_perm_b32 v97, v76, v72, s26
    v_perm_b32 v101, v76, v72, s27
    v_perm_b32 v105, v77, v73, s26
    v_perm_b32 v109, v77, v73, s27
    v_perm_b32 v113, v78, v74, s26
    v_perm_b32 v117, v78, v74, s27
    v_perm_b32 v121, v79, v75, s26
    v_perm_b32 v125, v79, v75, s27
    buffer_load_dwordx4 v[72:75], v115, s[4:7], 0 offen
    buffer_load_dwordx4 v[76:79], v119, s[4:7], 0 offen
    v_perm_b32 v98, v84, v80, s26
    v_perm_b32 v102, v84, v80, s27
    v_perm_b32 v106, v85, v81, s26
    v_perm_b32 v110, v85, v81, s27
    v_perm_b32 v114, v86, v82, s26
    v_perm_b32 v118, v86, v82, s27
    v_perm_b32 v122, v87, v83, s26
    v_perm_b32 v126, v87, v83, s27
    buffer_load_dwordx4 v[80:83], v123, s[4:7], 0 offen
    buffer_load_dwordx4 v[84:87], v127, s[4:7], 0 offen
    v_perm_b32 v99, v92, v88, s26
    v_perm_b32 v103, v92, v88, s27
    v_perm_b32 v107, v93, v89, s26
    v_perm_b32 v111, v93, v89, s27
    v_perm_b32 v115, v94, v90, s26
    v_perm_b32 v119, v94, v90, s27
    v_perm_b32 v123, v95, v91, s26
    v_perm_b32 v127, v95, v91, s27
    buffer_load_dwordx4 v[88:91], v4, s[4:7], 0 offen
    buffer_load_dwordx4 v[92:95], v5, s[4:7], 0 offen
L_k2_backp:
    v_add_u32_sdwa v4, s32, v2 dst_sel:DWORD dst_unused:UNUSED_PAD src0_sel:WORD_1 src1_sel:WORD_0
    v_mfma_f32_16x16x32_bf16 v[32:35], v[28:31], v[96:99], 0
    v_mfma_f32_16x16x32_bf16 v[36:39], v[28:31], v[100:103], 0
    ds_read_b64_tr_b16 v[98:99], v4 offset:61440
    v_perm_b32 v96, s38, v20, v22
    v_perm_b32 v97, s38, v20, v23
    v_mfma_f32_16x16x32_bf16 v[40:43], v[28:31], v[104:107], 0
    ds_read_b64_tr_b16 v[102:103], v4 offset:61472
    v_perm_b32 v100, s38, v21, v22
    v_perm_b32 v101, s38, v21, v23
    v_add_u32_sdwa v21, s33, v2 dst_sel:DWORD dst_unused:UNUSED_PAD src0_sel:WORD_1 src1_sel:WORD_1
    ds_read2_b32 v[20:21], v21 offset1:8
    s_setprio 1
    v_mfma_f32_16x16x32_bf16 v[44:47], v[28:31], v[108:111], 0
    v_mfma_f32_16x16x32_bf16 v[48:51], v[28:31], v[112:115], 0
    v_mfma_f32_16x16x32_bf16 v[52:55], v[28:31], v[116:119], 0
    v_mfma_f32_16x16x32_bf16 v[56:59], v[28:31], v[120:123], 0
    v_mfma_f32_16x16x32_bf16 v[60:63], v[28:31], v[124:127], 0
    s_waitcnt lgkmcnt(0)
    v_mfma_f32_4x4x4_16b_bf16 v[96:99], v[96:97], v[98:99], 0
    v_mfma_f32_4x4x4_16b_bf16 v[100:103], v[100:101], v[102:103], 0
    v_lshlrev_b32_sdwa v4, 9, v20 dst_sel:DWORD dst_unused:UNUSED_PAD src0_sel:DWORD src1_sel:WORD_1
    v_lshlrev_b32_sdwa v5, 9, v21 dst_sel:DWORD dst_unused:UNUSED_PAD src0_sel:DWORD src1_sel:WORD_1
L_k2_last:
    s_setprio 2
    s_bitcmp1_b32 s33, 5
    s_cbranch_scc1 L_k2_nonel
    s_add_u32 s33, s33, s29
    s_bitcmp1_b32 s33, 5
    s_cbranch_scc0 L_gd_11
    ds_append v0 offset:256
L_gd_11:
    v_cvt_pk_bf16_f32 v28, v96, v97
    v_cvt_pk_bf16_f32 v29, v98, v99
    v_cvt_pk_bf16_f32 v30, v100, v101
    v_cvt_pk_bf16_f32 v31, v102, v103
    v_add_u32_dpp v107, v4, v1 row_newbcast:12 row_mask:0xf bank_mask:0xf
    v_add_u32_dpp v111, v4, v1 row_newbcast:13 row_mask:0xf bank_mask:0xf
    v_add_u32_dpp v115, v4, v1 row_newbcast:14 row_mask:0xf bank_mask:0xf
    v_add_u32_dpp v119, v4, v1 row_newbcast:15 row_mask:0xf bank_mask:0xf
    v_add_u32_dpp v123, v5, v1 row_newbcast:12 row_mask:0xf bank_mask:0xf
    v_add_u32_dpp v127, v5, v1 row_newbcast:13 row_mask:0xf bank_mask:0xf
    v_add_u32_dpp v4, v5, v1 row_newbcast:14 row_mask:0xf bank_mask:0xf
    v_add_u32_dpp v5, v5, v1 row_newbcast:15 row_mask:0xf bank_mask:0xf
    s_waitcnt vmcnt(0)
    v_perm_b32 v96, v68, v64, s26
    v_perm_b32 v100, v68, v64, s27
    v_perm_b32 v104, v69, v65, s26
    v_perm_b32 v108, v69, v65, s27
    v_perm_b32 v112, v70, v66, s26
    v_perm_b32 v116, v70, v66, s27
    v_perm_b32 v120, v71, v67, s26
    v_perm_b32 v124, v71, v67, s27
    buffer_load_dwordx4 v[64:67], v107, s[4:7], 0 offen
    buffer_load_dwordx4 v[68:71], v111, s[4:7], 0 offen
    v_perm_b32 v97, v76, v72, s26
    v_perm_b32 v101, v76, v72, s27
    v_perm_b32 v105, v77, v73, s26
    v_perm_b32 v109, v77, v73, s27
    v_perm_b32 v113, v78, v74, s26
    v_perm_b32 v117, v78, v74, s27
    v_perm_b32 v121, v79, v75, s26
    v_perm_b32 v125, v79, v75, s27
    buffer_load_dwordx4 v[72:75], v115, s[4:7], 0 offen
    buffer_load_dwordx4 v[76:79], v119, s[4:7], 0 offen
    v_perm_b32 v98, v84, v80, s26
    v_perm_b32 v102, v84, v80, s27
    v_perm_b32 v106, v85, v81, s26
    v_perm_b32 v110, v85, v81, s27
    v_perm_b32 v114, v86, v82, s26
    v_perm_b32 v118, v86, v82, s27
    v_perm_b32 v122, v87, v83, s26
    v_perm_b32 v126, v87, v83, s27
    buffer_load_dwordx4 v[80:83], v123, s[4:7], 0 offen
    buffer_load_dwordx4 v[84:87], v127, s[4:7], 0 offen
    v_perm_b32 v99, v92, v88, s26
    v_perm_b32 v103, v92, v88, s27
    v_perm_b32 v107, v93, v89, s26
    v_perm_b32 v111, v93, v89, s27
    v_perm_b32 v115, v94, v90, s26
    v_perm_b32 v119, v94, v90, s27
    v_perm_b32 v123, v95, v91, s26
    v_perm_b32 v127, v95, v91, s27
    buffer_load_dwordx4 v[88:91], v4, s[4:7], 0 offen
    buffer_load_dwordx4 v[92:95], v5, s[4:7], 0 offen
L_k2_backl:
    v_add_u32_sdwa v4, s33, v2 dst_sel:DWORD dst_unused:UNUSED_PAD src0_sel:WORD_1 src1_sel:WORD_0
    v_mfma_f32_16x16x32_bf16 v[32:35], v[28:31], v[96:99], v[32:35]
    v_mfma_f32_16x16x32_bf16 v[36:39], v[28:31], v[100:103], v[36:39]
    ds_read_b64_tr_b16 v[98:99], v4 offset:61376
    v_perm_b32 v96, s38, v20, v22
    v_perm_b32 v97, s38, v20, v23
    v_mfma_f32_16x16x32_bf16 v[40:43], v[28:31], v[104:107], v[40:43]
    ds_read_b64_tr_b16 v[102:103], v4 offset:61408
    v_perm_b32 v100, s38, v21, v22
    v_perm_b32 v101, s38, v21, v23
    v_add_u32_sdwa v21, s33, v2 dst_sel:DWORD dst_unused:UNUSED_PAD src0_sel:WORD_1 src1_sel:WORD_1
    ds_read2_b32 v[20:21], v21 offset1:8
    s_setprio 1
    v_mfma_f32_16x16x32_bf16 v[44:47], v[28:31], v[108:111], v[44:47]
    v_mfma_f32_16x16x32_bf16 v[48:51], v[28:31], v[112:115], v[48:51]
    v_mfma_f32_16x16x32_bf16 v[52:55], v[28:31], v[116:119], v[52:55]
    v_mfma_f32_16x16x32_bf16 v[56:59], v[28:31], v[120:123], v[56:59]
    v_mfma_f32_16x16x32_bf16 v[60:63], v[28:31], v[124:127], v[60:63]
    s_waitcnt lgkmcnt(0)
    v_mfma_f32_4x4x4_16b_bf16 v[96:99], v[96:97], v[98:99], 0
    v_mfma_f32_4x4x4_16b_bf16 v[100:103], v[100:101], v[102:103], 0
    v_lshlrev_b32_sdwa v4, 9, v20 dst_sel:DWORD dst_unused:UNUSED_PAD src0_sel:DWORD src1_sel:WORD_1
    v_lshlrev_b32_sdwa v5, 9, v21 dst_sel:DWORD dst_unused:UNUSED_PAD src0_sel:DWORD src1_sel:WORD_1
L_k2_flush:
    ds_read_b128 v[112:115], v7 offset:5120
    ds_read_b128 v[116:119], v7 offset:6144
    ds_read_b128 v[120:123], v7 offset:7168
    ds_read_b128 v[124:127], v7 offset:8192
    v_cvt_pk_bf16_f32 v28, v96, v97
    v_cvt_pk_bf16_f32 v29, v98, v99
    v_cvt_pk_bf16_f32 v30, v100, v101
    v_cvt_pk_bf16_f32 v31, v102, v103
    s_bfe_u32 s24, s32, 0x60006
    s_mulk_i32 s24, 1056
    v_mul_f32 v96, v24, v32
    v_mul_f32 v100, v12, v36
    v_mul_f32 v104, v16, v40
    v_mul_f32 v108, v8, v44
    v_fmac_f32 v96, v25, v33
    v_fmac_f32 v100, v13, v37
    v_fmac_f32 v104, v17, v41
    v_fmac_f32 v108, v9, v45
    v_fmac_f32 v96, v26, v34
    v_fmac_f32 v100, v14, v38
    v_fmac_f32 v104, v18, v42
    v_fmac_f32 v108, v10, v46
    v_fmac_f32 v96, v27, v35
    v_fmac_f32 v100, v15, v39
    v_fmac_f32 v104, v19, v43
    v_fmac_f32 v108, v11, v47
    s_waitcnt lgkmcnt(0)
    v_mul_f32 v112, v112, v48
    v_mul_f32 v116, v116, v52
    v_mul_f32 v120, v120, v56
    v_mul_f32 v124, v124, v60
    v_fmac_f32 v112, v113, v49
    v_fmac_f32 v116, v117, v53
    v_fmac_f32 v120, v121, v57
    v_fmac_f32 v124, v125, v61
    v_fmac_f32 v112, v114, v50
    v_fmac_f32 v116, v118, v54
    v_fmac_f32 v120, v122, v58
    v_fmac_f32 v124, v126, v62
    v_fmac_f32 v112, v115, v51
    v_fmac_f32 v116, v119, v55
    v_fmac_f32 v120, v123, v59
    v_fmac_f32 v124, v127, v63
    v_add_u32 v101, s24, v6
    v_cvt_pk_bf16_f32 v96, v96, v100
    v_cvt_pk_bf16_f32 v97, v104, v108
    v_cvt_pk_bf16_f32 v98, v112, v116
    v_cvt_pk_bf16_f32 v99, v120, v124
    s_and_b32 s23, s33, s36
    s_cbranch_scc1 L_k2_cons
    ds_write_b128 v101, v[96:99]
    s_mov_b64 exec, 1
    v_and_b32_sdwa v102, s32, 28 dst_sel:DWORD dst_unused:UNUSED_PAD src0_sel:BYTE_1 src1_sel:DWORD
    ds_inc_u32 v102, v6 offset:272
    s_mov_b64 exec, -1
L_k2_first:
    s_setprio 3
    s_bitcmp1_b32 s33, 5
    s_cbranch_scc1 L_k2_partf
    s_add_u32 s33, s33, s29
    s_bitcmp1_b32 s33, 5
    s_cbranch_scc0 L_gd_12
    ds_append v0 offset:256
L_gd_12:
    v_add_u32_dpp v107, v4, v1 row_newbcast:12 row_mask:0xf bank_mask:0xf
    v_add_u32_dpp v111, v4, v1 row_newbcast:13 row_mask:0xf bank_mask:0xf
    v_add_u32_dpp v115, v4, v1 row_newbcast:14 row_mask:0xf bank_mask:0xf
    v_add_u32_dpp v119, v4, v1 row_newbcast:15 row_mask:0xf bank_mask:0xf
    v_add_u32_dpp v123, v5, v1 row_newbcast:12 row_mask:0xf bank_mask:0xf
    v_add_u32_dpp v127, v5, v1 row_newbcast:13 row_mask:0xf bank_mask:0xf
    v_add_u32_dpp v4, v5, v1 row_newbcast:14 row_mask:0xf bank_mask:0xf
    v_add_u32_dpp v5, v5, v1 row_newbcast:15 row_mask:0xf bank_mask:0xf
    s_waitcnt vmcnt(0)
    v_perm_b32 v96, v68, v64, s26
    v_perm_b32 v100, v68, v64, s27
    v_perm_b32 v104, v69, v65, s26
    v_perm_b32 v108, v69, v65, s27
    v_perm_b32 v112, v70, v66, s26
    v_perm_b32 v116, v70, v66, s27
    v_perm_b32 v120, v71, v67, s26
    v_perm_b32 v124, v71, v67, s27
    buffer_load_dwordx4 v[64:67], v107, s[4:7], 0 offen
    buffer_load_dwordx4 v[68:71], v111, s[4:7], 0 offen
    v_perm_b32 v97, v76, v72, s26
    v_perm_b32 v101, v76, v72, s27
    v_perm_b32 v105, v77, v73, s26
    v_perm_b32 v109, v77, v73, s27
    v_perm_b32 v113, v78, v74, s26
    v_perm_b32 v117, v78, v74, s27
    v_perm_b32 v121, v79, v75, s26
    v_perm_b32 v125, v79, v75, s27
    buffer_load_dwordx4 v[72:75], v115, s[4:7], 0 offen
    buffer_load_dwordx4 v[76:79], v119, s[4:7], 0 offen
    v_perm_b32 v98, v84, v80, s26
    v_perm_b32 v102, v84, v80, s27
    v_perm_b32 v106, v85, v81, s26
    v_perm_b32 v110, v85, v81, s27
    v_perm_b32 v114, v86, v82, s26
    v_perm_b32 v118, v86, v82, s27
    v_perm_b32 v122, v87, v83, s26
    v_perm_b32 v126, v87, v83, s27
    buffer_load_dwordx4 v[80:83], v123, s[4:7], 0 offen
    buffer_load_dwordx4 v[84:87], v127, s[4:7], 0 offen
    v_perm_b32 v99, v92, v88, s26
    v_perm_b32 v103, v92, v88, s27
    v_perm_b32 v107, v93, v89, s26
    v_perm_b32 v111, v93, v89, s27
    v_perm_b32 v115, v94, v90, s26
    v_perm_b32 v119, v94, v90, s27
    v_perm_b32 v123, v95, v91, s26
    v_perm_b32 v127, v95, v91, s27
    buffer_load_dwordx4 v[88:91], v4, s[4:7], 0 offen
    buffer_load_dwordx4 v[92:95], v5, s[4:7], 0 offen
    v_add_u32_sdwa v4, s33, v2 dst_sel:DWORD dst_unused:UNUSED_PAD src0_sel:WORD_1 src1_sel:WORD_0
    v_mfma_f32_16x16x32_bf16 v[32:35], v[28:31], v[96:99], 0
    v_mfma_f32_16x16x32_bf16 v[36:39], v[28:31], v[100:103], 0
    ds_read_b64_tr_b16 v[98:99], v4 offset:61376
    v_perm_b32 v96, s38, v20, v22
    v_perm_b32 v97, s38, v20, v23
    v_mfma_f32_16x16x32_bf16 v[40:43], v[28:31], v[104:107], 0
    ds_read_b64_tr_b16 v[102:103], v4 offset:61408
    v_perm_b32 v100, s38, v21, v22
    v_perm_b32 v101, s38, v21, v23
    v_add_u32_sdwa v21, s33, v2 dst_sel:DWORD dst_unused:UNUSED_PAD src0_sel:WORD_1 src1_sel:WORD_1
    ds_read2_b32 v[20:21], v21 offset1:8
    s_setprio 1
    v_mfma_f32_16x16x32_bf16 v[44:47], v[28:31], v[108:111], 0
    v_mfma_f32_16x16x32_bf16 v[48:51], v[28:31], v[112:115], 0
    v_mfma_f32_16x16x32_bf16 v[52:55], v[28:31], v[116:119], 0
    v_mfma_f32_16x16x32_bf16 v[56:59], v[28:31], v[120:123], 0
    v_mfma_f32_16x16x32_bf16 v[60:63], v[28:31], v[124:127], 0
    s_waitcnt lgkmcnt(0)
    v_mfma_f32_4x4x4_16b_bf16 v[96:99], v[96:97], v[98:99], 0
    v_mfma_f32_4x4x4_16b_bf16 v[100:103], v[100:101], v[102:103], 0
    v_lshlrev_b32_sdwa v4, 9, v20 dst_sel:DWORD dst_unused:UNUSED_PAD src0_sel:DWORD src1_sel:WORD_1
    v_lshlrev_b32_sdwa v5, 9, v21 dst_sel:DWORD dst_unused:UNUSED_PAD src0_sel:DWORD src1_sel:WORD_1
L_k2_mid:
    s_bitcmp1_b32 s33, 5
    s_cbranch_scc0 L_k2_more
    v_cvt_pk_bf16_f32 v28, v96, v97
    v_cvt_pk_bf16_f32 v29, v98, v99
    v_cvt_pk_bf16_f32 v30, v100, v101
    v_cvt_pk_bf16_f32 v31, v102, v103
    v_readfirstlane_b32 s22, v0
    s_mov_b32 s32, s33
    s_cmp_ge_u32 s22, s30
    s_cbranch_scc1 L_gr_13
L_gb_14:
    s_lshr_b32 s22, s22, 6
    v_readlane_b32 s33, v3, s22
L_gd_15:
    s_bitcmp1_b32 s32, 2
    s_cbranch_scc0 L_k2_more1
    s_bitcmp1_b32 s32, 1
    s_cbranch_scc1 L_k2_tq2
    s_bitcmp1_b32 s32, 0
    s_cbranch_scc1 L_k2_tq1
    v_add_u32_dpp v107, v4, v1 row_newbcast:12 row_mask:0xf bank_mask:0xf
    v_add_u32_dpp v111, v4, v1 row_newbcast:13 row_mask:0xf bank_mask:0xf
    v_add_u32_dpp v115, v4, v1 row_newbcast:14 row_mask:0xf bank_mask:0xf
    v_add_u32_dpp v119, v4, v1 row_newbcast:15 row_mask:0xf bank_mask:0xf
    s_waitcnt vmcnt(0)
    v_perm_b32 v96, v68, v64, s26
    v_perm_b32 v100, v68, v64, s27
    v_perm_b32 v104, v69, v65, s26
    v_perm_b32 v108, v69, v65, s27
    v_perm_b32 v112, v70, v66, s26
    v_perm_b32 v116, v70, v66, s27
    v_perm_b32 v120, v71, v67, s26
    v_perm_b32 v124, v71, v67, s27
    buffer_load_dwordx4 v[64:67], v107, s[4:7], 0 offen
    buffer_load_dwordx4 v[68:71], v111, s[4:7], 0 offen
    v_perm_b32 v97, v76, v72, s26
    v_perm_b32 v101, v76, v72, s27
    v_perm_b32 v105, v77, v73, s26
    v_perm_b32 v109, v77, v73, s27
    v_perm_b32 v113, v78, v74, s26
    v_perm_b32 v117, v78, v74, s27
    v_perm_b32 v121, v79, v75, s26
    v_perm_b32 v125, v79, v75, s27
    buffer_load_dwordx4 v[72:75], v115, s[4:7], 0 offen
    buffer_load_dwordx4 v[76:79], v119, s[4:7], 0 offen
    v_perm_b32 v98, v84, v80, s26
    v_perm_b32 v102, v84, v80, s27
    v_perm_b32 v106, v85, v81, s26
    v_perm_b32 v110, v85, v81, s27
    v_perm_b32 v114, v86, v82, s26
    v_perm_b32 v118, v86, v82, s27
    v_perm_b32 v122, v87, v83, s26
    v_perm_b32 v126, v87, v83, s27
    v_perm_b32 v99, v92, v88, s26
    v_perm_b32 v103, v92, v88, s27
    v_perm_b32 v107, v93, v89, s26
    v_perm_b32 v111, v93, v89, s27
    v_perm_b32 v115, v94, v90, s26
    v_perm_b32 v119, v94, v90, s27
    v_perm_b32 v123, v95, v91, s26
    v_perm_b32 v127, v95, v91, s27
    s_branch L_k2_backq
L_k2_tq1:
    v_add_u32_dpp v107, v4, v1 row_newbcast:12 row_mask:0xf bank_mask:0xf
    v_add_u32_dpp v111, v4, v1 row_newbcast:13 row_mask:0xf bank_mask:0xf
    v_add_u32_dpp v115, v4, v1 row_newbcast:14 row_mask:0xf bank_mask:0xf
    s_waitcnt vmcnt(0)
    v_perm_b32 v96, v68, v64, s26
    v_perm_b32 v100, v68, v64, s27
    v_perm_b32 v104, v69, v65, s26
    v_perm_b32 v108, v69, v65, s27
    v_perm_b32 v112, v70, v66, s26
    v_perm_b32 v116, v70, v66, s27
    v_perm_b32 v120, v71, v67, s26
    v_perm_b32 v124, v71, v67, s27
    buffer_load_dwordx4 v[64:67], v107, s[4:7], 0 offen
    buffer_load_dwordx4 v[68:71], v111, s[4:7], 0 offen
    v_perm_b32 v97, v76, v72, s26
    v_perm_b32 v101, v76, v72, s27
    v_perm_b32 v105, v77, v73, s26
    v_perm_b32 v109, v77, v73, s27
    v_perm_b32 v113, v78, v74, s26
    v_perm_b32 v117, v78, v74, s27
    v_perm_b32 v121, v79, v75, s26
    v_perm_b32 v125, v79, v75, s27
    buffer_load_dwordx4 v[72:75], v115, s[4:7], 0 offen
    v_perm_b32 v98, v84, v80, s26
    v_perm_b32 v102, v84, v80, s27
    v_perm_b32 v106, v85, v81, s26
    v_perm_b32 v110, v85, v81, s27
    v_perm_b32 v114, v86, v82, s26
    v_perm_b32 v118, v86, v82, s27
    v_perm_b32 v122, v87, v83, s26
    v_perm_b32 v126, v87, v83, s27
    v_perm_b32 v99, v92, v88, s26
    v_perm_b32 v103, v92, v88, s27
    v_perm_b32 v107, v93, v89, s26
    v_perm_b32 v111, v93, v89, s27
    v_perm_b32 v115, v94, v90, s26
    v_perm_b32 v119, v94, v90, s27
    v_perm_b32 v123, v95, v91, s26
    v_perm_b32 v127, v95, v91, s27
    s_branch L_k2_backq
L_k2_tq2:
    s_bitcmp1_b32 s32, 0
    s_cbranch_scc1 L_k2_tq3
    v_add_u32_dpp v107, v4, v1 row_newbcast:12 row_mask:0xf bank_mask:0xf
    v_add_u32_dpp v111, v4, v1 row_newbcast:13 row_mask:0xf bank_mask:0xf
    s_waitcnt vmcnt(0)
    v_perm_b32 v96, v68, v64, s26
    v_perm_b32 v100, v68, v64, s27
    v_perm_b32 v104, v69, v65, s26
    v_perm_b32 v108, v69, v65, s27
    v_perm_b32 v112, v70, v66, s26
    v_perm_b32 v116, v70, v66, s27
    v_perm_b32 v120, v71, v67, s26
    v_perm_b32 v124, v71, v67, s27
    buffer_load_dwordx4 v[64:67], v107, s[4:7], 0 offen
    buffer_load_dwordx4 v[68:71], v111, s[4:7], 0 offen
    v_perm_b32 v97, v76, v72, s26
    v_perm_b32 v101, v76, v72, s27
    v_perm_b32 v105, v77, v73, s26
    v_perm_b32 v109, v77, v73, s27
    v_perm_b32 v113, v78, v74, s26
    v_perm_b32 v117, v78, v74, s27
    v_perm_b32 v121, v79, v75, s26
    v_perm_b32 v125, v79, v75, s27
    v_perm_b32 v98, v84, v80, s26
    v_perm_b32 v102, v84, v80, s27
    v_perm_b32 v106, v85, v81, s26
    v_perm_b32 v110, v85, v81, s27
    v_perm_b32 v114, v86, v82, s26
    v_perm_b32 v118, v86, v82, s27
    v_perm_b32 v122, v87, v83, s26
    v_perm_b32 v126, v87, v83, s27
    v_perm_b32 v99, v92, v88, s26
    v_perm_b32 v103, v92, v88, s27
    v_perm_b32 v107, v93, v89, s26
    v_perm_b32 v111, v93, v89, s27
    v_perm_b32 v115, v94, v90, s26
    v_perm_b32 v119, v94, v90, s27
    v_perm_b32 v123, v95, v91, s26
    v_perm_b32 v127, v95, v91, s27
    s_branch L_k2_backq
L_k2_tq3:
    v_add_u32_dpp v107, v4, v1 row_newbcast:12 row_mask:0xf bank_mask:0xf
    s_waitcnt vmcnt(0)
    v_perm_b32 v96, v68, v64, s26
    v_perm_b32 v100, v68, v64, s27
    v_perm_b32 v104, v69, v65, s26
    v_perm_b32 v108, v69, v65, s27
    v_perm_b32 v112, v70, v66, s26
    v_perm_b32 v116, v70, v66, s27
    v_perm_b32 v120, v71, v67, s26
    v_perm_b32 v124, v71, v67, s27
    buffer_load_dwordx4 v[64:67], v107, s[4:7], 0 offen
    v_perm_b32 v97, v76, v72, s26
    v_perm_b32 v101, v76, v72, s27
    v_perm_b32 v105, v77, v73, s26
    v_perm_b32 v109, v77, v73, s27
    v_perm_b32 v113, v78, v74, s26
    v_perm_b32 v117, v78, v74, s27
    v_perm_b32 v121, v79, v75, s26
    v_perm_b32 v125, v79, v75, s27
    v_perm_b32 v98, v84, v80, s26
    v_perm_b32 v102, v84, v80, s27
    v_perm_b32 v106, v85, v81, s26
    v_perm_b32 v110, v85, v81, s27
    v_perm_b32 v114, v86, v82, s26
    v_perm_b32 v118, v86, v82, s27
    v_perm_b32 v122, v87, v83, s26
    v_perm_b32 v126, v87, v83, s27
    v_perm_b32 v99, v92, v88, s26
    v_perm_b32 v103, v92, v88, s27
    v_perm_b32 v107, v93, v89, s26
    v_perm_b32 v111, v93, v89, s27
    v_perm_b32 v115, v94, v90, s26
    v_perm_b32 v119, v94, v90, s27
    v_perm_b32 v123, v95, v91, s26
    v_perm_b32 v127, v95, v91, s27
L_k2_backq:
    v_add_u32_sdwa v4, s32, v2 dst_sel:DWORD dst_unused:UNUSED_PAD src0_sel:WORD_1 src1_sel:WORD_0
    v_mfma_f32_16x16x32_bf16 v[32:35], v[28:31], v[96:99], v[32:35]
    v_mfma_f32_16x16x32_bf16 v[36:39], v[28:31], v[100:103], v[36:39]
    ds_read_b64_tr_b16 v[98:99], v4 offset:61440
    v_perm_b32 v96, s38, v20, v22
    v_perm_b32 v97, s38, v20, v23
    v_add_u32_sdwa v21, s33, v2 dst_sel:DWORD dst_unused:UNUSED_PAD src0_sel:WORD_1 src1_sel:WORD_1
    ds_read2_b32 v[20:21], v21 offset1:8
    v_mfma_f32_16x16x32_bf16 v[40:43], v[28:31], v[104:107], v[40:43]
    s_setprio 0
    v_mfma_f32_16x16x32_bf16 v[44:47], v[28:31], v[108:111], v[44:47]
    v_mfma_f32_16x16x32_bf16 v[48:51], v[28:31], v[112:115], v[48:51]
    v_mfma_f32_16x16x32_bf16 v[52:55], v[28:31], v[116:119], v[52:55]
    v_mfma_f32_16x16x32_bf16 v[56:59], v[28:31], v[120:123], v[56:59]
    v_mfma_f32_16x16x32_bf16 v[60:63], v[28:31], v[124:127], v[60:63]
    s_waitcnt lgkmcnt(0)
    v_mfma_f32_4x4x4_16b_bf16 v[96:99], v[96:97], v[98:99], 0
    v_lshlrev_b32_sdwa v4, 9, v20 dst_sel:DWORD dst_unused:UNUSED_PAD src0_sel:DWORD src1_sel:WORD_1
    v_lshlrev_b32_sdwa v5, 9, v21 dst_sel:DWORD dst_unused:UNUSED_PAD src0_sel:DWORD src1_sel:WORD_1
    s_bitcmp1_b32 s33, 5
    s_cbranch_scc1 L_k2_noneh
    s_add_u32 s33, s33, s29
    s_bitcmp1_b32 s33, 5
    s_cbranch_scc0 L_gd_16
    ds_append v0 offset:256
L_gd_16:
    v_cvt_pk_bf16_f32 v28, v96, v97
    v_cvt_pk_bf16_f32 v29, v98, v99
    v_add_u32_dpp v107, v4, v1 row_newbcast:12 row_mask:0xf bank_mask:0xf
    v_add_u32_dpp v111, v4, v1 row_newbcast:13 row_mask:0xf bank_mask:0xf
    v_add_u32_dpp v115, v4, v1 row_newbcast:14 row_mask:0xf bank_mask:0xf
    v_add_u32_dpp v119, v4, v1 row_newbcast:15 row_mask:0xf bank_mask:0xf
    v_add_u32_dpp v123, v5, v1 row_newbcast:12 row_mask:0xf bank_mask:0xf
    v_add_u32_dpp v127, v5, v1 row_newbcast:13 row_mask:0xf bank_mask:0xf
    v_add_u32_dpp v4, v5, v1 row_newbcast:14 row_mask:0xf bank_mask:0xf
    v_add_u32_dpp v5, v5, v1 row_newbcast:15 row_mask:0xf bank_mask:0xf
    buffer_load_dwordx4 v[80:83], v123, s[4:7], 0 offen
    buffer_load_dwordx4 v[84:87], v127, s[4:7], 0 offen
    buffer_load_dwordx4 v[88:91], v4, s[4:7], 0 offen
    buffer_load_dwordx4 v[92:95], v5, s[4:7], 0 offen
    s_waitcnt vmcnt(4)
    v_perm_b32 v96, v68, v64, s26
    v_perm_b32 v100, v68, v64, s27
    v_perm_b32 v104, v69, v65, s26
    v_perm_b32 v108, v69, v65, s27
    v_perm_b32 v112, v70, v66, s26
    v_perm_b32 v116, v70, v66, s27
    v_perm_b32 v120, v71, v67, s26
    v_perm_b32 v124, v71, v67, s27
    buffer_load_dwordx4 v[64:67], v107, s[4:7], 0 offen
    buffer_load_dwordx4 v[68:71], v111, s[4:7], 0 offen
    v_perm_b32 v97, v76, v72, s26
    v_perm_b32 v101, v76, v72, s27
    v_perm_b32 v105, v77, v73, s26
    v_perm_b32 v109, v77, v73, s27
    v_perm_b32 v113, v78, v74, s26
    v_perm_b32 v117, v78, v74, s27
    v_perm_b32 v121, v79, v75, s26
    v_perm_b32 v125, v79, v75, s27
    buffer_load_dwordx4 v[72:75], v115, s[4:7], 0 offen
    buffer_load_dwordx4 v[76:79], v119, s[4:7], 0 offen
L_k2_backh:
    v_add_u32_sdwa v4, s33, v2 dst_sel:DWORD dst_unused:UNUSED_PAD src0_sel:WORD_1 src1_sel:WORD_0
    v_mfma_f32_16x16x16_bf16 v[32:35], v[28:29], v[96:97], v[32:35]
    v_mfma_f32_16x16x16_bf16 v[36:39], v[28:29], v[100:101], v[36:39]
    ds_read_b64_tr_b16 v[98:99], v4 offset:61376
    v_perm_b32 v96, s38, v20, v22
    v_perm_b32 v97, s38, v20, v23
    v_mfma_f32_16x16x16_bf16 v[40:43], v[28:29], v[104:105], v[40:43]
    ds_read_b64_tr_b16 v[102:103], v4 offset:61408
    v_perm_b32 v100, s38, v21, v22
    v_perm_b32 v101, s38, v21, v23
    v_add_u32_sdwa v21, s33, v2 dst_sel:DWORD dst_unused:UNUSED_PAD src0_sel:WORD_1 src1_sel:WORD_1
    ds_read2_b32 v[20:21], v21 offset1:8
    s_setprio 1
    v_mfma_f32_16x16x16_bf16 v[44:47], v[28:29], v[108:109], v[44:47]
    v_mfma_f32_16x16x16_bf16 v[48:51], v[28:29], v[112:113], v[48:51]
    v_mfma_f32_16x16x16_bf16 v[52:55], v[28:29], v[116:117], v[52:55]
    v_mfma_f32_16x16x16_bf16 v[56:59], v[28:29], v[120:121], v[56:59]
    v_mfma_f32_16x16x16_bf16 v[60:63], v[28:29], v[124:125], v[60:63]
    s_waitcnt lgkmcnt(0)
    v_mfma_f32_4x4x4_16b_bf16 v[96:99], v[96:97], v[98:99], 0
    v_mfma_f32_4x4x4_16b_bf16 v[100:103], v[100:101], v[102:103], 0
    v_lshlrev_b32_sdwa v4, 9, v20 dst_sel:DWORD dst_unused:UNUSED_PAD src0_sel:DWORD src1_sel:WORD_1
    v_lshlrev_b32_sdwa v5, 9, v21 dst_sel:DWORD dst_unused:UNUSED_PAD src0_sel:DWORD src1_sel:WORD_1
    s_branch L_k2_flush
L_k2_more:
    v_cvt_pk_bf16_f32 v28, v96, v97
    v_cvt_pk_bf16_f32 v29, v98, v99
    v_cvt_pk_bf16_f32 v30, v100, v101
    v_cvt_pk_bf16_f32 v31, v102, v103
    s_mov_b32 s32, s33
    s_add_u32 s33, s33, s29
    s_bitcmp1_b32 s33, 5
    s_cbranch_scc0 L_gd_17
    ds_append v0 offset:256
L_gd_17:
L_k2_more1:
    v_add_u32_dpp v107, v4, v1 row_newbcast:12 row_mask:0xf bank_mask:0xf
    v_add_u32_dpp v111, v4, v1 row_newbcast:13 row_mask:0xf bank_mask:0xf
    v_add_u32_dpp v115, v4, v1 row_newbcast:14 row_mask:0xf bank_mask:0xf
    v_add_u32_dpp v119, v4, v1 row_newbcast:15 row_mask:0xf bank_mask:0xf
    v_add_u32_dpp v123, v5, v1 row_newbcast:12 row_mask:0xf bank_mask:0xf
    v_add_u32_dpp v127, v5, v1 row_newbcast:13 row_mask:0xf bank_mask:0xf
    v_add_u32_dpp v4, v5, v1 row_newbcast:14 row_mask:0xf bank_mask:0xf
    v_add_u32_dpp v5, v5, v1 row_newbcast:15 row_mask:0xf bank_mask:0xf
    s_waitcnt vmcnt(0)
    v_perm_b32 v96, v68, v64, s26
    v_perm_b32 v100, v68, v64, s27
    v_perm_b32 v104, v69, v65, s26
    v_perm_b32 v108, v69, v65, s27
    v_perm_b32 v112, v70, v66, s26
    v_perm_b32 v116, v70, v66, s27
    v_perm_b32 v120, v71, v67, s26
    v_perm_b32 v124, v71, v67, s27
    buffer_load_dwordx4 v[64:67], v107, s[4:7], 0 offen
    buffer_load_dwordx4 v[68:71], v111, s[4:7], 0 offen
    v_perm_b32 v97, v76, v72, s26
    v_perm_b32 v101, v76, v72, s27
    v_perm_b32 v105, v77, v73, s26
    v_perm_b32 v109, v77, v73, s27
    v_perm_b32 v113, v78, v74, s26
    v_perm_b32 v117, v78, v74, s27
    v_perm_b32 v121, v79, v75, s26
    v_perm_b32 v125, v79, v75, s27
    buffer_load_dwordx4 v[72:75], v115, s[4:7], 0 offen
    buffer_load_dwordx4 v[76:79], v119, s[4:7], 0 offen
    v_perm_b32 v98, v84, v80, s26
    v_perm_b32 v102, v84, v80, s27
    v_perm_b32 v106, v85, v81, s26
    v_perm_b32 v110, v85, v81, s27
    v_perm_b32 v114, v86, v82, s26
    v_perm_b32 v118, v86, v82, s27
    v_perm_b32 v122, v87, v83, s26
    v_perm_b32 v126, v87, v83, s27
    buffer_load_dwordx4 v[80:83], v123, s[4:7], 0 offen
    buffer_load_dwordx4 v[84:87], v127, s[4:7], 0 offen
    v_perm_b32 v99, v92, v88, s26
    v_perm_b32 v103, v92, v88, s27
    v_perm_b32 v107, v93, v89, s26
    v_perm_b32 v111, v93, v89, s27
    v_perm_b32 v115, v94, v90, s26
    v_perm_b32 v119, v94, v90, s27
    v_perm_b32 v123, v95, v91, s26
    v_perm_b32 v127, v95, v91, s27
    buffer_load_dwordx4 v[88:91], v4, s[4:7], 0 offen
    buffer_load_dwordx4 v[92:95], v5, s[4:7], 0 offen
    v_add_u32_sdwa v4, s32, v2 dst_sel:DWORD dst_unused:UNUSED_PAD src0_sel:WORD_1 src1_sel:WORD_0
    v_mfma_f32_16x16x32_bf16 v[32:35], v[28:31], v[96:99], v[32:35]
    v_mfma_f32_16x16x32_bf16 v[36:39], v[28:31], v[100:103], v[36:39]
    ds_read_b64_tr_b16 v[98:99], v4 offset:61440
    v_perm_b32 v96, s38, v20, v22
    v_perm_b32 v97, s38, v20, v23
    v_mfma_f32_16x16x32_bf16 v[40:43], v[28:31], v[104:107], v[40:43]
    ds_read_b64_tr_b16 v[102:103], v4 offset:61472
    v_perm_b32 v100, s38, v21, v22
    v_perm_b32 v101, s38, v21, v23
    v_add_u32_sdwa v21, s33, v2 dst_sel:DWORD dst_unused:UNUSED_PAD src0_sel:WORD_1 src1_sel:WORD_1
    ds_read2_b32 v[20:21], v21 offset1:8
    s_setprio 1
    v_mfma_f32_16x16x32_bf16 v[44:47], v[28:31], v[108:111], v[44:47]
    v_mfma_f32_16x16x32_bf16 v[48:51], v[28:31], v[112:115], v[48:51]
    v_mfma_f32_16x16x32_bf16 v[52:55], v[28:31], v[116:119], v[52:55]
    v_mfma_f32_16x16x32_bf16 v[56:59], v[28:31], v[120:123], v[56:59]
    v_mfma_f32_16x16x32_bf16 v[60:63], v[28:31], v[124:127], v[60:63]
    s_waitcnt lgkmcnt(0)
    v_mfma_f32_4x4x4_16b_bf16 v[96:99], v[96:97], v[98:99], 0
    v_mfma_f32_4x4x4_16b_bf16 v[100:103], v[100:101], v[102:103], 0
    v_lshlrev_b32_sdwa v4, 9, v20 dst_sel:DWORD dst_unused:UNUSED_PAD src0_sel:DWORD src1_sel:WORD_1
    v_lshlrev_b32_sdwa v5, 9, v21 dst_sel:DWORD dst_unused:UNUSED_PAD src0_sel:DWORD src1_sel:WORD_1
    s_bitcmp1_b32 s32, 5
    s_cbranch_scc1 L_k2_last
    s_branch L_k2_mid
L_k2_nonel:
    s_setprio 0
    ds_read_b128 v[112:115], v7 offset:5120
    ds_read_b128 v[116:119], v7 offset:6144
    ds_read_b128 v[120:123], v7 offset:7168
    ds_read_b128 v[124:127], v7 offset:8192
    s_bfe_u32 s24, s32, 0x60006
    s_mulk_i32 s24, 1056
    v_cvt_pk_bf16_f32 v28, v96, v97
    v_cvt_pk_bf16_f32 v29, v98, v99
    v_cvt_pk_bf16_f32 v30, v100, v101
    v_cvt_pk_bf16_f32 v31, v102, v103
    v_add_u32 v4, s24, v6
    v_and_b32_sdwa v5, s32, 28 dst_sel:DWORD dst_unused:UNUSED_PAD src0_sel:BYTE_1 src1_sel:DWORD
    s_waitcnt vmcnt(0) lgkmcnt(0)
    v_perm_b32 v96, v68, v64, s26
    v_perm_b32 v97, v76, v72, s26
    v_perm_b32 v98, v84, v80, s26
    v_perm_b32 v99, v92, v88, s26
    v_perm_b32 v100, v68, v64, s27
    v_perm_b32 v101, v76, v72, s27
    v_perm_b32 v102, v84, v80, s27
    v_perm_b32 v103, v92, v88, s27
    v_mfma_f32_16x16x32_bf16 v[32:35], v[28:31], v[96:99], v[32:35]
    v_perm_b32 v104, v69, v65, s26
    v_perm_b32 v105, v77, v73, s26
    v_perm_b32 v106, v85, v81, s26
    v_perm_b32 v107, v93, v89, s26
    v_mfma_f32_16x16x32_bf16 v[36:39], v[28:31], v[100:103], v[36:39]
    v_perm_b32 v108, v69, v65, s27
    v_perm_b32 v109, v77, v73, s27
    v_perm_b32 v110, v85, v81, s27
    v_perm_b32 v111, v93, v89, s27
    v_mfma_f32_16x16x32_bf16 v[40:43], v[28:31], v[104:107], v[40:43]
    v_perm_b32 v96, v70, v66, s26
    v_perm_b32 v97, v78, v74, s26
    v_perm_b32 v98, v86, v82, s26
    v_perm_b32 v99, v94, v90, s26
    v_mfma_f32_16x16x32_bf16 v[44:47], v[28:31], v[108:111], v[44:47]
    v_perm_b32 v100, v70, v66, s27
    v_perm_b32 v101, v78, v74, s27
    v_perm_b32 v102, v86, v82, s27
    v_perm_b32 v103, v94, v90, s27
    v_mfma_f32_16x16x32_bf16 v[48:51], v[28:31], v[96:99], v[48:51]
    v_perm_b32 v104, v71, v67, s26
    v_perm_b32 v105, v79, v75, s26
    v_perm_b32 v106, v87, v83, s26
    v_perm_b32 v107, v95, v91, s26
    v_mfma_f32_16x16x32_bf16 v[52:55], v[28:31], v[100:103], v[52:55]
    v_perm_b32 v108, v71, v67, s27
    v_perm_b32 v109, v79, v75, s27
    v_perm_b32 v110, v87, v83, s27
    v_perm_b32 v111, v95, v91, s27
    v_mfma_f32_16x16x32_bf16 v[56:59], v[28:31], v[104:107], v[56:59]
    v_mul_f32 v32, v24, v32
    v_mul_f32 v36, v12, v36
    v_mfma_f32_16x16x32_bf16 v[60:63], v[28:31], v[108:111], v[60:63]
    v_fmac_f32 v32, v25, v33
    v_fmac_f32 v36, v13, v37
    v_fmac_f32 v32, v26, v34
    v_fmac_f32 v36, v14, v38
    v_fmac_f32 v32, v27, v35
    v_fmac_f32 v36, v15, v39
    v_mul_f32 v40, v16, v40
    v_mul_f32 v44, v8, v44
    v_fmac_f32 v40, v17, v41
    v_fmac_f32 v44, v9, v45
    v_fmac_f32 v40, v18, v42
    v_fmac_f32 v44, v10, v46
    v_fmac_f32 v40, v19, v43
    v_fmac_f32 v44, v11, v47
    v_mul_f32 v48, v112, v48
    v_mul_f32 v52, v116, v52
    v_fmac_f32 v48, v113, v49
    v_fmac_f32 v52, v117, v53
    v_fmac_f32 v48, v114, v50
    v_fmac_f32 v52, v118, v54
    v_fmac_f32 v48, v115, v51
    v_fmac_f32 v52, v119, v55
    v_cvt_pk_bf16_f32 v96, v32, v36
    v_cvt_pk_bf16_f32 v97, v40, v44
    v_cvt_pk_bf16_f32 v98, v48, v52
    v_mul_f32 v56, v120, v56
    v_mul_f32 v60, v124, v60
    v_fmac_f32 v56, v121, v57
    v_fmac_f32 v60, v125, v61
    v_fmac_f32 v56, v122, v58
    v_fmac_f32 v60, v126, v62
    v_fmac_f32 v56, v123, v59
    v_fmac_f32 v60, v127, v63
    s_bitcmp1_b32 s36, 12
    v_cvt_pk_bf16_f32 v99, v56, v60
    s_cbranch_scc1 L_k2_cons
    ds_write_b128 v4, v[96:99]
    s_mov_b64 exec, 1
    ds_inc_u32 v5, v6 offset:272
    s_mov_b64 exec, -1
    s_branch L_k2_gdone
L_k2_noneh:
    s_setprio 0
    ds_read_b128 v[112:115], v7 offset:5120
    ds_read_b128 v[116:119], v7 offset:6144
    ds_read_b128 v[120:123], v7 offset:7168
    ds_read_b128 v[124:127], v7 offset:8192
    s_bfe_u32 s24, s32, 0x60006
    s_mulk_i32 s24, 1056
    v_cvt_pk_bf16_f32 v28, v96, v97
    v_cvt_pk_bf16_f32 v29, v98, v99
    v_add_u32 v4, s24, v6
    v_and_b32_sdwa v5, s32, 28 dst_sel:DWORD dst_unused:UNUSED_PAD src0_sel:BYTE_1 src1_sel:DWORD
    s_waitcnt vmcnt(0) lgkmcnt(0)
    v_perm_b32 v96, v68, v64, s26
    v_perm_b32 v97, v76, v72, s26
    v_perm_b32 v100, v68, v64, s27
    v_perm_b32 v101, v76, v72, s27
    v_mfma_f32_16x16x16_bf16 v[32:35], v[28:29], v[96:97], v[32:35]
    v_perm_b32 v104, v69, v65, s26
    v_perm_b32 v105, v77, v73, s26
    v_mfma_f32_16x16x16_bf16 v[36:39], v[28:29], v[100:101], v[36:39]
    v_perm_b32 v108, v69, v65, s27
    v_perm_b32 v109, v77, v73, s27
    v_mfma_f32_16x16x16_bf16 v[40:43], v[28:29], v[104:105], v[40:43]
    v_perm_b32 v96, v70, v66, s26
    v_perm_b32 v97, v78, v74, s26
    v_mfma_f32_16x16x16_bf16 v[44:47], v[28:29], v[108:109], v[44:47]
    v_perm_b32 v100, v70, v66, s27
    v_perm_b32 v101, v78, v74, s27
    v_mfma_f32_16x16x16_bf16 v[48:51], v[28:29], v[96:97], v[48:51]
    v_mul_f32 v32, v24, v32
    v_mul_f32 v36, v12, v36
    v_perm_b32 v104, v71, v67, s26
    v_perm_b32 v105, v79, v75, s26
    v_mfma_f32_16x16x16_bf16 v[52:55], v[28:29], v[100:101], v[52:55]
    v_fmac_f32 v32, v25, v33
    v_fmac_f32 v36, v13, v37
    v_perm_b32 v108, v71, v67, s27
    v_perm_b32 v109, v79, v75, s27
    v_mfma_f32_16x16x16_bf16 v[56:59], v[28:29], v[104:105], v[56:59]
    v_fmac_f32 v32, v26, v34
    v_fmac_f32 v36, v14, v38
    v_fmac_f32 v32, v27, v35
    v_fmac_f32 v36, v15, v39
    v_mfma_f32_16x16x16_bf16 v[60:63], v[28:29], v[108:109], v[60:63]
    v_mul_f32 v40, v16, v40
    v_mul_f32 v44, v8, v44
    v_fmac_f32 v40, v17, v41
    v_fmac_f32 v44, v9, v45
    v_fmac_f32 v40, v18, v42
    v_fmac_f32 v44, v10, v46
    v_fmac_f32 v40, v19, v43
    v_fmac_f32 v44, v11, v47
    v_mul_f32 v48, v112, v48
    v_mul_f32 v52, v116, v52
    v_fmac_f32 v48, v113, v49
    v_fmac_f32 v52, v117, v53
    v_fmac_f32 v48, v114, v50
    v_fmac_f32 v52, v118, v54
    v_fmac_f32 v48, v115, v51
    v_fmac_f32 v52, v119, v55
    v_cvt_pk_bf16_f32 v96, v32, v36
    v_cvt_pk_bf16_f32 v97, v40, v44
    v_cvt_pk_bf16_f32 v98, v48, v52
    v_mul_f32 v56, v120, v56
    v_mul_f32 v60, v124, v60
    v_fmac_f32 v56, v121, v57
    v_fmac_f32 v60, v125, v61
    v_fmac_f32 v56, v122, v58
    v_fmac_f32 v60, v126, v62
    v_fmac_f32 v56, v123, v59
    v_fmac_f32 v60, v127, v63
    s_bitcmp1_b32 s36, 12
    v_cvt_pk_bf16_f32 v99, v56, v60
    s_cbranch_scc1 L_k2_cons
    ds_write_b128 v4, v[96:99]
    s_mov_b64 exec, 1
    ds_inc_u32 v5, v6 offset:272
    s_mov_b64 exec, -1
    s_branch L_k2_gdone
L_k2_cons:
    v_add_u32 v101, s24, v6
    v_mov_b32 v103, 0
    s_bitcmp1_b32 s32, 12
    s_cbranch_scc1 L_k2_consb
L_k2_wrd:
    ds_read_b32 v104, v103 offset:336
    s_movk_i32 s36, 0x3000
    s_waitcnt lgkmcnt(0)
    v_cmp_gt_u32 vcc, 0x100, v104
    s_cbranch_vccnz L_k2_wrd
    s_branch L_k2_consok
L_k2_consb:
    s_bitcmp1_b32 s36, 12
    s_cbranch_scc0 L_k2_consok
    v_and_b32_sdwa v102, s32, 12 dst_sel:DWORD dst_unused:UNUSED_PAD src0_sel:BYTE_1 src1_sel:DWORD
L_k2_conspoll:
    ds_read_b32 v104, v102 offset:304
    ds_read_b32 v105, v103 offset:304
    s_waitcnt lgkmcnt(0)
    v_readfirstlane_b32 s23, v104
    v_readfirstlane_b32 s24, v105
    s_cmp_lt_u32 s23, 4
    s_cbranch_scc1 L_k2_conspoll
    s_cmp_lt_u32 s24, 4
    s_cselect_b32 s36, s36, 0x2000
L_k2_consok:
    ds_write_b128 v101, v[96:99]
    s_mov_b64 exec, 1
    v_and_b32_sdwa v102, s32, 28 dst_sel:DWORD dst_unused:UNUSED_PAD src0_sel:BYTE_1 src1_sel:DWORD
    ds_inc_u32 v102, v6 offset:272
    s_mov_b64 exec, -1
    s_bitcmp1_b32 s33, 13
    s_cbranch_scc1 L_k2_gdone
    s_xor_b32 s23, s33, s32
    s_bitcmp1_b32 s23, 12
    s_cbranch_scc0 L_k2_first
    v_add_u32 v7, 0x2000, v7
    ds_read_b128 v[24:27], v7 offset:1024
    ds_read_b128 v[12:15], v7 offset:2048
    ds_read_b128 v[16:19], v7 offset:3072
    ds_read_b128 v[8:11], v7 offset:4096
    s_branch L_k2_first
L_gr_8:
    s_movk_i32 s30, 6272
    s_mov_b32 s33, 0x402028
    s_cmp_ge_u32 s22, s30
    s_cbranch_scc1 L_gd_10
    v_lshrrev_b32 v96, 2, v7
    ds_read_b32 v3, v96 offset:768
    v_add_u32 v1, 0x100, v1
    v_subrev_u32 v4, 0x100, v4
    v_subrev_u32 v5, 0x100, v5
    s_waitcnt lgkmcnt(0)
    s_branch L_gb_9
L_gr_13:
    s_movk_i32 s30, 6272
    s_mov_b32 s33, 0x402028
    s_cmp_ge_u32 s22, s30
    s_cbranch_scc1 L_gd_15
    v_lshrrev_b32 v96, 2, v7
    ds_read_b32 v3, v96 offset:768
    v_add_u32 v1, 0x100, v1
    v_subrev_u32 v4, 0x100, v4
    v_subrev_u32 v5, 0x100, v5
    s_waitcnt lgkmcnt(0)
    s_branch L_gb_14
L_k2_gdone:
    s_cmp_lg_u32 s18, 0
    s_cbranch_scc1 L_k2_next
    s_endpgm
L_k2_cw:
    ds_read_b32 v13, v24 offset:0
    s_branch L_k2_cw1
L_k2_spec:
    s_setprio 0
    v_and_b32 v0, 63, v0
    v_sub_u32 v4, v26, v13
    v_bfe_u32 v60, v0, 4, 2
    v_mul_u32_u24 v60, 100, v60
    v_bfe_u32 v61, v0, 2, 2
    v_add_lshl_u32 v60, v60, v61, 4
    v_and_or_b32 v60, v0, 3, v60
    s_lshl_b32 s62, s16, 5
    s_add_u32 s62, s62, 104960
    v_lshl_add_u32 v60, v60, 3, s62
    ds_read_b64_tr_b16 v[20:21], v60 offset:0
    ds_read_b64_tr_b16 v[22:23], v60 offset:512
    ds_read_b64_tr_b16 v[24:25], v60 offset:1024
    ds_read_b64_tr_b16 v[26:27], v60 offset:1536
    ds_read_b64_tr_b16 v[28:29], v60 offset:2048
    ds_read_b64_tr_b16 v[30:31], v60 offset:2560
    ds_read_b64_tr_b16 v[32:33], v60 offset:3072
    ds_read_b64_tr_b16 v[34:35], v60 offset:3584
    ds_read_b64_tr_b16 v[36:37], v60 offset:4096
    ds_read_b64_tr_b16 v[38:39], v60 offset:4608
    ds_read_b64_tr_b16 v[40:41], v60 offset:5120
    ds_read_b64_tr_b16 v[42:43], v60 offset:5632
    ds_read_b64_tr_b16 v[44:45], v60 offset:6144
    ds_read_b64_tr_b16 v[46:47], v60 offset:6656
    ds_read_b64_tr_b16 v[48:49], v60 offset:7168
    ds_read_b64_tr_b16 v[50:51], v60 offset:7680
    ds_read_b64_tr_b16 v[52:53], v60 offset:8192
    ds_read_b64_tr_b16 v[54:55], v60 offset:8704
    ds_read_b64_tr_b16 v[56:57], v60 offset:9216
    ds_read_b64_tr_b16 v[58:59], v60 offset:9728
    s_cmp_lg_u32 s16, 13
    s_cbranch_scc1 L_k2_nosort
    v_add_lshl_u32 v6, v0, 49, 2
    v_or_b32 v4, 0x1000, v4
    v_and_b32 v6, 0xfc, v6
    ds_write_b32 v6, v4 offset:768
L_k2_nosort:
    ds_append v63 offset:336
    v_and_b32 v4, 15, v0
    v_bfe_u32 v5, v0, 4, 2
    v_mul_u32_u24 v60, 1056, v4
    v_lshl_add_u32 v60, v5, 4, v60
    v_add_u32 v60, 105344, v60
    s_sub_u32 s22, s16, 12
    v_mul_u32_u24 v1, 528, v4
    v_lshl_add_u32 v1, v5, 3, v1
    s_lshl_b32 s23, s22, 5
    s_add_u32 s23, s23, 61440
    v_add_u32 v1, s23, v1
    v_bfe_u32 v4, v0, 5, 1
    v_lshl_add_u32 v4, s22, 2, v4
    v_and_b32 v5, 31, v0
    v_lshlrev_b32 v5, 4, v5
    v_mul_u32_u24 v2, 528, v4
    s_mov_b32 s23, 61440
    v_add3_u32 v2, v2, v5, s23
    s_lshl_b32 s23, s3, 9
    v_lshlrev_b32 v61, 17, v4
    v_add3_u32 v61, v61, v5, s23
    s_mov_b32 s24, 0xbfb8aa3b
    s_waitcnt vmcnt(0) lgkmcnt(0)
    s_cmp_eq_u32 s28, 0
    s_cbranch_scc1 L_k2_wd
    v_mov_b64 v[64:65], 0
    v_mov_b64 v[66:67], 0
    v_mov_b64 v[68:69], 0
    v_mov_b64 v[70:71], 0
    v_mov_b64 v[72:73], 0
    v_mov_b64 v[74:75], 0
    v_mov_b64 v[76:77], 0
    v_mov_b64 v[78:79], 0
    v_mov_b64 v[80:81], 0
    v_mov_b64 v[82:83], 0
    v_mov_b64 v[84:85], 0
    v_mov_b64 v[86:87], 0
    v_mov_b64 v[88:89], 0
    v_mov_b64 v[90:91], 0
    v_mov_b64 v[92:93], 0
    v_mov_b64 v[94:95], 0
    v_mov_b64 v[96:97], 0
    v_mov_b64 v[98:99], 0
    v_mov_b64 v[100:101], 0
    v_mov_b64 v[102:103], 0
    v_mov_b64 v[104:105], 0
    v_mov_b64 v[106:107], 0
    v_mov_b64 v[108:109], 0
    v_mov_b64 v[110:111], 0
    v_mov_b64 v[112:113], 0
    v_mov_b64 v[114:115], 0
    v_mov_b64 v[116:117], 0
    v_mov_b64 v[118:119], 0
    v_mov_b64 v[120:121], 0
    v_mov_b64 v[122:123], 0
    v_mov_b64 v[124:125], 0
    v_mov_b64 v[126:127], 0
    s_lshl_b32 s22, s2, 4
    s_add_u32 s22, s22, s16
    s_cmp_lg_u32 s22, 15
    s_cbranch_scc1 L_k2_wd
    s_mov_b64 exec, 15
    v_lshlrev_b32 v4, 2, v0
    ds_read_b32 v6, v4 offset:512
    v_lshlrev_b32 v4, 1, v4
    s_mov_b32 s22, 0xd80004
    s_waitcnt lgkmcnt(0)
    buffer_store_dword v6, v4, s[12:15], s22 offen sc1
    s_mov_b64 exec, -1
L_k2_wd:
    v_mov_b32 v62, 0
L_poll_18:
    ds_read_b32 v63, v62 offset:284
    s_waitcnt lgkmcnt(0)
    v_readfirstlane_b32 s22, v63
    s_cmp_ge_u32 s22, 1
    s_cbranch_scc1 L_go_19
    s_sleep 2
    s_branch L_poll_18
L_go_19:
    v_mov_b64 v[4:5], 0
    v_mov_b64 v[6:7], 0
    v_mov_b64 v[8:9], 0
    v_mov_b64 v[10:11], 0
    v_mov_b64 v[12:13], 0
    v_mov_b64 v[14:15], 0
    v_mov_b64 v[16:17], 0
    v_mov_b64 v[18:19], 0
    s_mov_b32 exec_lo, 0x00010001
    s_mov_b32 exec_hi, 0x00010001
    ds_read_b128 v[4:7], v60 offset:50688
    ds_read_b128 v[8:11], v60 offset:50752
    ds_read_b128 v[12:15], v60 offset:50816
    ds_read_b128 v[16:19], v60 offset:50880
    s_waitcnt lgkmcnt(3)
    v_mfma_f32_16x16x32_bf16 v[112:115], v[20:23], v[4:7], v[112:115]
    ds_read_b128 v[4:7], v60 offset:50944
    s_waitcnt lgkmcnt(3)
    v_mfma_f32_16x16x32_bf16 v[112:115], v[24:27], v[8:11], v[112:115]
    ds_read_b128 v[8:11], v60 offset:51008
    s_waitcnt lgkmcnt(3)
    v_mfma_f32_16x16x32_bf16 v[116:119], v[44:47], v[12:15], v[116:119]
    ds_read_b128 v[12:15], v60 offset:51072
    s_waitcnt lgkmcnt(3)
    v_mfma_f32_16x16x32_bf16 v[116:119], v[48:51], v[16:19], v[116:119]
    ds_read_b128 v[16:19], v60 offset:51136
    s_waitcnt lgkmcnt(3)
    v_mfma_f32_16x16x32_bf16 v[116:119], v[36:39], v[4:7], v[116:119]
    ds_read_b128 v[4:7], v60 offset:51200
    s_waitcnt lgkmcnt(3)
    v_mfma_f32_16x16x32_bf16 v[116:119], v[40:43], v[8:11], v[116:119]
    ds_read_b128 v[8:11], v60 offset:51264
    s_waitcnt lgkmcnt(3)
    v_mfma_f32_16x16x32_bf16 v[112:115], v[28:31], v[12:15], v[112:115]
    ds_read_b128 v[12:15], v60 offset:51328
    s_waitcnt lgkmcnt(3)
    v_mfma_f32_16x16x32_bf16 v[112:115], v[32:35], v[16:19], v[112:115]
    ds_read_b128 v[16:19], v60 offset:51392
    s_waitcnt lgkmcnt(3)
    v_mfma_f32_16x16x32_bf16 v[120:123], v[36:39], v[4:7], v[120:123]
    ds_read_b128 v[4:7], v60 offset:51456
    s_waitcnt lgkmcnt(3)
    v_mfma_f32_16x16x32_bf16 v[120:123], v[40:43], v[8:11], v[120:123]
    ds_read_b128 v[8:11], v60 offset:51520
    s_waitcnt lgkmcnt(3)
    v_mfma_f32_16x16x32_bf16 v[124:127], v[52:55], v[12:15], v[124:127]
    ds_read_b128 v[12:15], v60 offset:51584
    s_waitcnt lgkmcnt(3)
    v_mfma_f32_16x16x32_bf16 v[124:127], v[56:59], v[16:19], v[124:127]
    ds_read_b128 v[16:19], v60 offset:51648
    s_waitcnt lgkmcnt(3)
    v_mfma_f32_16x16x32_bf16 v[124:127], v[36:39], v[4:7], v[124:127]
    s_waitcnt lgkmcnt(2)
    v_mfma_f32_16x16x32_bf16 v[124:127], v[40:43], v[8:11], v[124:127]
    s_waitcnt lgkmcnt(1)
    v_mfma_f32_16x16x32_bf16 v[120:123], v[52:55], v[12:15], v[120:123]
    s_waitcnt lgkmcnt(0)
    v_mfma_f32_16x16x32_bf16 v[120:123], v[56:59], v[16:19], v[120:123]
    s_mov_b64 exec, -1
    v_mov_b32 v63, 1
    s_mov_b64 exec, 1
    ds_add_u32 v62, v63 offset:316
    s_mov_b64 exec, -1
    s_mul_i32 s22, s2, 49*512
    s_mul_i32 s23, s16, 12*512
    s_add_u32 s22, s22, s23
    s_sub_u32 s22, s22, 73472
    s_min_u32 s22, s22, 6393600
    s_add_u32 s23, s22, 6656
L_spf_21:
    s_buffer_load_dword s40, s[4:7], s22 offset:0
    s_buffer_load_dword s41, s[4:7], s22 offset:64
    s_buffer_load_dword s42, s[4:7], s22 offset:128
    s_buffer_load_dword s43, s[4:7], s22 offset:192
    s_add_u32 s22, s22, 512
    s_cmp_lt_u32 s22, s23
    s_waitcnt lgkmcnt(2)
    s_cbranch_scc1 L_spf_21
    s_waitcnt lgkmcnt(0)
    v_mov_b32 v62, 0
L_poll_22:
    ds_read_b32 v63, v62 offset:280
    s_waitcnt lgkmcnt(0)
    v_readfirstlane_b32 s22, v63
    s_cmp_ge_u32 s22, 16
    s_cbranch_scc1 L_go_23
    s_sleep 2
    s_branch L_poll_22
L_go_23:
    ds_read_b128 v[4:7], v60 offset:33792
    ds_read_b128 v[8:11], v60 offset:33856
    ds_read_b128 v[12:15], v60 offset:33920
    ds_read_b128 v[16:19], v60 offset:33984
    s_waitcnt lgkmcnt(3)
    v_mfma_f32_16x16x32_bf16 v[96:99], v[20:23], v[4:7], v[96:99]
    ds_read_b128 v[4:7], v60 offset:34048
    s_waitcnt lgkmcnt(3)
    v_mfma_f32_16x16x32_bf16 v[96:99], v[24:27], v[8:11], v[96:99]
    ds_read_b128 v[8:11], v60 offset:34112
    s_waitcnt lgkmcnt(3)
    v_mfma_f32_16x16x32_bf16 v[100:103], v[44:47], v[12:15], v[100:103]
    ds_read_b128 v[12:15], v60 offset:34176
    s_waitcnt lgkmcnt(3)
    v_mfma_f32_16x16x32_bf16 v[100:103], v[48:51], v[16:19], v[100:103]
    ds_read_b128 v[16:19], v60 offset:34240
    s_waitcnt lgkmcnt(3)
    v_mfma_f32_16x16x32_bf16 v[100:103], v[36:39], v[4:7], v[100:103]
    ds_read_b128 v[4:7], v60 offset:34304
    s_waitcnt lgkmcnt(3)
    v_mfma_f32_16x16x32_bf16 v[100:103], v[40:43], v[8:11], v[100:103]
    ds_read_b128 v[8:11], v60 offset:34368
    s_waitcnt lgkmcnt(3)
    v_mfma_f32_16x16x32_bf16 v[96:99], v[28:31], v[12:15], v[96:99]
    ds_read_b128 v[12:15], v60 offset:34432
    s_waitcnt lgkmcnt(3)
    v_mfma_f32_16x16x32_bf16 v[96:99], v[32:35], v[16:19], v[96:99]
    ds_read_b128 v[16:19], v60 offset:34496
    s_waitcnt lgkmcnt(3)
    v_mfma_f32_16x16x32_bf16 v[104:107], v[36:39], v[4:7], v[104:107]
    ds_read_b128 v[4:7], v60 offset:34560
    s_waitcnt lgkmcnt(3)
    v_mfma_f32_16x16x32_bf16 v[104:107], v[40:43], v[8:11], v[104:107]
    ds_read_b128 v[8:11], v60 offset:34624
    s_waitcnt lgkmcnt(3)
    v_mfma_f32_16x16x32_bf16 v[108:111], v[52:55], v[12:15], v[108:111]
    ds_read_b128 v[12:15], v60 offset:34688
    s_waitcnt lgkmcnt(3)
    v_mfma_f32_16x16x32_bf16 v[108:111], v[56:59], v[16:19], v[108:111]
    ds_read_b128 v[16:19], v60 offset:34752
    s_waitcnt lgkmcnt(3)
    v_mfma_f32_16x16x32_bf16 v[108:111], v[36:39], v[4:7], v[108:111]
    s_waitcnt lgkmcnt(2)
    v_mfma_f32_16x16x32_bf16 v[108:111], v[40:43], v[8:11], v[108:111]
    s_waitcnt lgkmcnt(1)
    v_mfma_f32_16x16x32_bf16 v[104:107], v[52:55], v[12:15], v[104:107]
    s_waitcnt lgkmcnt(0)
    v_mfma_f32_16x16x32_bf16 v[104:107], v[56:59], v[16:19], v[104:107]
    v_mov_b32 v63, 1
    s_mov_b64 exec, 1
    ds_add_u32 v62, v63 offset:312
    s_mov_b64 exec, -1
    v_mov_b32 v62, 0
L_poll_25:
    ds_read_b32 v63, v62 offset:276
    s_waitcnt lgkmcnt(0)
    v_readfirstlane_b32 s22, v63
    s_cmp_ge_u32 s22, 16
    s_cbranch_scc1 L_go_26
    s_sleep 2
    s_branch L_poll_25
L_go_26:
    ds_read_b128 v[4:7], v60 offset:16896
    ds_read_b128 v[8:11], v60 offset:16960
    ds_read_b128 v[12:15], v60 offset:17024
    ds_read_b128 v[16:19], v60 offset:17088
    s_waitcnt lgkmcnt(3)
    v_mfma_f32_16x16x32_bf16 v[80:83], v[20:23], v[4:7], v[80:83]
    ds_read_b128 v[4:7], v60 offset:17152
    s_waitcnt lgkmcnt(3)
    v_mfma_f32_16x16x32_bf16 v[80:83], v[24:27], v[8:11], v[80:83]
    ds_read_b128 v[8:11], v60 offset:17216
    s_waitcnt lgkmcnt(3)
    v_mfma_f32_16x16x32_bf16 v[84:87], v[44:47], v[12:15], v[84:87]
    ds_read_b128 v[12:15], v60 offset:17280
    s_waitcnt lgkmcnt(3)
    v_mfma_f32_16x16x32_bf16 v[84:87], v[48:51], v[16:19], v[84:87]
    ds_read_b128 v[16:19], v60 offset:17344
    s_waitcnt lgkmcnt(3)
    v_mfma_f32_16x16x32_bf16 v[84:87], v[36:39], v[4:7], v[84:87]
    ds_read_b128 v[4:7], v60 offset:17408
    s_waitcnt lgkmcnt(3)
    v_mfma_f32_16x16x32_bf16 v[84:87], v[40:43], v[8:11], v[84:87]
    ds_read_b128 v[8:11], v60 offset:17472
    s_waitcnt lgkmcnt(3)
    v_mfma_f32_16x16x32_bf16 v[80:83], v[28:31], v[12:15], v[80:83]
    ds_read_b128 v[12:15], v60 offset:17536
    s_waitcnt lgkmcnt(3)
    v_mfma_f32_16x16x32_bf16 v[80:83], v[32:35], v[16:19], v[80:83]
    ds_read_b128 v[16:19], v60 offset:17600
    s_waitcnt lgkmcnt(3)
    v_mfma_f32_16x16x32_bf16 v[88:91], v[36:39], v[4:7], v[88:91]
    ds_read_b128 v[4:7], v60 offset:17664
    s_waitcnt lgkmcnt(3)
    v_mfma_f32_16x16x32_bf16 v[88:91], v[40:43], v[8:11], v[88:91]
    ds_read_b128 v[8:11], v60 offset:17728
    s_waitcnt lgkmcnt(3)
    v_mfma_f32_16x16x32_bf16 v[92:95], v[52:55], v[12:15], v[92:95]
    ds_read_b128 v[12:15], v60 offset:17792
    s_waitcnt lgkmcnt(3)
    v_mfma_f32_16x16x32_bf16 v[92:95], v[56:59], v[16:19], v[92:95]
    ds_read_b128 v[16:19], v60 offset:17856
    s_waitcnt lgkmcnt(3)
    v_mfma_f32_16x16x32_bf16 v[92:95], v[36:39], v[4:7], v[92:95]
    s_waitcnt lgkmcnt(2)
    v_mfma_f32_16x16x32_bf16 v[92:95], v[40:43], v[8:11], v[92:95]
    s_waitcnt lgkmcnt(1)
    v_mfma_f32_16x16x32_bf16 v[88:91], v[52:55], v[12:15], v[88:91]
    s_waitcnt lgkmcnt(0)
    v_mfma_f32_16x16x32_bf16 v[88:91], v[56:59], v[16:19], v[88:91]
    v_mov_b32 v63, 1
    s_mov_b64 exec, 1
    ds_add_u32 v62, v63 offset:308
    s_mov_b64 exec, -1
    v_mov_b32 v62, 0
L_poll_28:
    ds_read_b32 v63, v62 offset:272
    s_waitcnt lgkmcnt(0)
    v_readfirstlane_b32 s22, v63
    s_cmp_ge_u32 s22, 16
    s_cbranch_scc1 L_go_29
    s_sleep 2
    s_branch L_poll_28
L_go_29:
    ds_read_b128 v[4:7], v60 offset:0
    ds_read_b128 v[8:11], v60 offset:64
    ds_read_b128 v[12:15], v60 offset:128
    ds_read_b128 v[16:19], v60 offset:192
    s_waitcnt lgkmcnt(3)
    v_mfma_f32_16x16x32_bf16 v[64:67], v[20:23], v[4:7], v[64:67]
    ds_read_b128 v[4:7], v60 offset:256
    s_waitcnt lgkmcnt(3)
    v_mfma_f32_16x16x32_bf16 v[64:67], v[24:27], v[8:11], v[64:67]
    ds_read_b128 v[8:11], v60 offset:320
    s_waitcnt lgkmcnt(3)
    v_mfma_f32_16x16x32_bf16 v[68:71], v[44:47], v[12:15], v[68:71]
    ds_read_b128 v[12:15], v60 offset:384
    s_waitcnt lgkmcnt(3)
    v_mfma_f32_16x16x32_bf16 v[68:71], v[48:51], v[16:19], v[68:71]
    ds_read_b128 v[16:19], v60 offset:448
    s_waitcnt lgkmcnt(3)
    v_mfma_f32_16x16x32_bf16 v[68:71], v[36:39], v[4:7], v[68:71]
    ds_read_b128 v[4:7], v60 offset:512
    s_waitcnt lgkmcnt(3)
    v_mfma_f32_16x16x32_bf16 v[68:71], v[40:43], v[8:11], v[68:71]
    ds_read_b128 v[8:11], v60 offset:576
    s_waitcnt lgkmcnt(3)
    v_mfma_f32_16x16x32_bf16 v[64:67], v[28:31], v[12:15], v[64:67]
    ds_read_b128 v[12:15], v60 offset:640
    s_waitcnt lgkmcnt(3)
    v_mfma_f32_16x16x32_bf16 v[64:67], v[32:35], v[16:19], v[64:67]
    ds_read_b128 v[16:19], v60 offset:704
    s_waitcnt lgkmcnt(3)
    v_mfma_f32_16x16x32_bf16 v[72:75], v[36:39], v[4:7], v[72:75]
    ds_read_b128 v[4:7], v60 offset:768
    s_waitcnt lgkmcnt(3)
    v_mfma_f32_16x16x32_bf16 v[72:75], v[40:43], v[8:11], v[72:75]
    ds_read_b128 v[8:11], v60 offset:832
    s_waitcnt lgkmcnt(3)
    v_mfma_f32_16x16x32_bf16 v[76:79], v[52:55], v[12:15], v[76:79]
    ds_read_b128 v[12:15], v60 offset:896
    s_waitcnt lgkmcnt(3)
    v_mfma_f32_16x16x32_bf16 v[76:79], v[56:59], v[16:19], v[76:79]
    ds_read_b128 v[16:19], v60 offset:960
    s_waitcnt lgkmcnt(3)
    v_mfma_f32_16x16x32_bf16 v[76:79], v[36:39], v[4:7], v[76:79]
    s_waitcnt lgkmcnt(2)
    v_mfma_f32_16x16x32_bf16 v[76:79], v[40:43], v[8:11], v[76:79]
    s_waitcnt lgkmcnt(1)
    v_mfma_f32_16x16x32_bf16 v[72:75], v[52:55], v[12:15], v[72:75]
    s_waitcnt lgkmcnt(0)
    v_mfma_f32_16x16x32_bf16 v[72:75], v[56:59], v[16:19], v[72:75]
    v_mov_b32 v63, 1
    s_mov_b64 exec, 1
    ds_add_u32 v62, v63 offset:304
    s_mov_b64 exec, -1
    v_mov_b32 v62, 0
L_poll_31:
    ds_read_b32 v63, v62 offset:300
    s_waitcnt lgkmcnt(0)
    v_readfirstlane_b32 s22, v63
    s_cmp_ge_u32 s22, 1
    s_cbranch_scc1 L_go_32
    s_sleep 2
    s_branch L_poll_31
L_go_32:
    v_mov_b64 v[4:5], 0
    v_mov_b64 v[6:7], 0
    v_mov_b64 v[8:9], 0
    v_mov_b64 v[10:11], 0
    v_mov_b64 v[12:13], 0
    v_mov_b64 v[14:15], 0
    v_mov_b64 v[16:17], 0
    v_mov_b64 v[18:19], 0
    s_mov_b32 exec_lo, 0x00010001
    s_mov_b32 exec_hi, 0x00010001
    ds_read_b128 v[4:7], v60 offset:50688
    ds_read_b128 v[8:11], v60 offset:50752
    ds_read_b128 v[12:15], v60 offset:50816
    ds_read_b128 v[16:19], v60 offset:50880
    s_waitcnt lgkmcnt(3)
    v_mfma_f32_16x16x32_bf16 v[120:123], v[44:47], v[4:7], v[120:123]
    ds_read_b128 v[4:7], v60 offset:50944
    s_waitcnt lgkmcnt(3)
    v_mfma_f32_16x16x32_bf16 v[120:123], v[48:51], v[8:11], v[120:123]
    ds_read_b128 v[8:11], v60 offset:51008
    s_waitcnt lgkmcnt(3)
    v_mfma_f32_16x16x32_bf16 v[124:127], v[44:47], v[12:15], v[124:127]
    ds_read_b128 v[12:15], v60 offset:51072
    s_waitcnt lgkmcnt(3)
    v_mfma_f32_16x16x32_bf16 v[124:127], v[48:51], v[16:19], v[124:127]
    ds_read_b128 v[16:19], v60 offset:51136
    s_waitcnt lgkmcnt(3)
    v_mfma_f32_16x16x32_bf16 v[124:127], v[52:55], v[4:7], v[124:127]
    ds_read_b128 v[4:7], v60 offset:51200
    s_waitcnt lgkmcnt(3)
    v_mfma_f32_16x16x32_bf16 v[124:127], v[56:59], v[8:11], v[124:127]
    ds_read_b128 v[8:11], v60 offset:51264
    s_waitcnt lgkmcnt(3)
    v_mfma_f32_16x16x32_bf16 v[120:123], v[52:55], v[12:15], v[120:123]
    ds_read_b128 v[12:15], v60 offset:51328
    s_waitcnt lgkmcnt(3)
    v_mfma_f32_16x16x32_bf16 v[120:123], v[56:59], v[16:19], v[120:123]
    ds_read_b128 v[16:19], v60 offset:51392
    s_waitcnt lgkmcnt(3)
    v_mfma_f32_16x16x32_bf16 v[112:115], v[28:31], v[4:7], v[112:115]
    ds_read_b128 v[4:7], v60 offset:51456
    s_waitcnt lgkmcnt(3)
    v_mfma_f32_16x16x32_bf16 v[112:115], v[32:35], v[8:11], v[112:115]
    ds_read_b128 v[8:11], v60 offset:51520
    s_waitcnt lgkmcnt(3)
    v_mfma_f32_16x16x32_bf16 v[116:119], v[52:55], v[12:15], v[116:119]
    ds_read_b128 v[12:15], v60 offset:51584
    s_waitcnt lgkmcnt(3)
    v_mfma_f32_16x16x32_bf16 v[116:119], v[56:59], v[16:19], v[116:119]
    ds_read_b128 v[16:19], v60 offset:51648
    s_waitcnt lgkmcnt(3)
    v_mfma_f32_16x16x32_bf16 v[116:119], v[52:55], v[4:7], v[116:119]
    s_waitcnt lgkmcnt(2)
    v_mfma_f32_16x16x32_bf16 v[116:119], v[56:59], v[8:11], v[116:119]
    s_waitcnt lgkmcnt(1)
    v_mfma_f32_16x16x32_bf16 v[112:115], v[28:31], v[12:15], v[112:115]
    s_waitcnt lgkmcnt(0)
    v_mfma_f32_16x16x32_bf16 v[112:115], v[32:35], v[16:19], v[112:115]
    s_mov_b64 exec, -1
    s_cmp_lg_u32 s18, 0
    s_cbranch_scc1 L_skip_33
    s_nop 7
    v_mul_f32 v4, s24, v112
    v_mul_f32 v5, s24, v113
    v_mul_f32 v6, s24, v114
    v_mul_f32 v7, s24, v115
    v_exp_f32 v4, v4
    v_exp_f32 v5, v5
    v_exp_f32 v6, v6
    v_exp_f32 v7, v7
    s_nop 0
    v_add_f32 v4, 1.0, v4
    v_add_f32 v5, 1.0, v5
    v_add_f32 v6, 1.0, v6
    v_add_f32 v7, 1.0, v7
    v_rcp_f32 v4, v4
    v_rcp_f32 v5, v5
    v_rcp_f32 v6, v6
    v_rcp_f32 v7, v7
    s_nop 0
    v_mul_f32 v116, v116, v4
    v_mul_f32 v117, v117, v5
    v_mul_f32 v118, v118, v6
    v_mul_f32 v119, v119, v7
    v_mul_f32 v120, v120, v4
    v_mul_f32 v121, v121, v5
    v_mul_f32 v122, v122, v6
    v_mul_f32 v123, v123, v7
    v_mul_f32 v124, v124, v4
    v_mul_f32 v125, v125, v5
    v_mul_f32 v126, v126, v6
    v_mul_f32 v127, v127, v7
    s_mov_b32 exec_lo, 0x00010001
    s_mov_b32 exec_hi, 0x00010001
    v_cvt_pk_bf16_f32 v12, v112, v113
    v_cvt_pk_bf16_f32 v13, v114, v115
    ds_write_b64 v1, v[12:13] offset:43008
    v_cvt_pk_bf16_f32 v14, v116, v117
    v_cvt_pk_bf16_f32 v15, v118, v119
    ds_write_b64 v1, v[14:15] offset:43136
    v_cvt_pk_bf16_f32 v16, v120, v121
    v_cvt_pk_bf16_f32 v17, v122, v123
    ds_write_b64 v1, v[16:17] offset:43264
    v_cvt_pk_bf16_f32 v18, v124, v125
    v_cvt_pk_bf16_f32 v19, v126, v127
    ds_write_b64 v1, v[18:19] offset:43392
    s_mov_b64 exec, -1
    ds_append v63 offset:332
    s_mov_b32 s25, 0x600000
    s_waitcnt lgkmcnt(0)
    v_readfirstlane_b32 s22, v63
    s_cmp_ge_u32 s22, 192
    s_cbranch_scc1 L_sg_35
L_sp_34:
    ds_read_b32 v63, v62 offset:332
    s_waitcnt lgkmcnt(0)
    v_readfirstlane_b32 s22, v63
    s_cmp_lt_u32 s22, 256
    s_cbranch_scc1 L_sp_34
L_sg_35:
    s_cmp_lg_u32 s16, 12
    s_cbranch_scc1 L_skip_33
    ds_read_b128 v[4:7], v2 offset:43008
    s_waitcnt lgkmcnt(0)
    buffer_store_dwordx4 v[4:7], v61, s[8:11], s25 offen sc1
    s_nop 1
L_skip_33:
    v_mov_b32 v62, 0
L_poll_36:
    ds_read_b32 v63, v62 offset:296
    s_waitcnt lgkmcnt(0)
    v_readfirstlane_b32 s22, v63
    s_cmp_ge_u32 s22, 16
    s_cbranch_scc1 L_go_37
    s_sleep 2
    s_branch L_poll_36
L_go_37:
    ds_read_b128 v[4:7], v60 offset:33792
    ds_read_b128 v[8:11], v60 offset:33856
    ds_read_b128 v[12:15], v60 offset:33920
    ds_read_b128 v[16:19], v60 offset:33984
    s_waitcnt lgkmcnt(3)
    v_mfma_f32_16x16x32_bf16 v[104:107], v[44:47], v[4:7], v[104:107]
    ds_read_b128 v[4:7], v60 offset:34048
    s_waitcnt lgkmcnt(3)
    v_mfma_f32_16x16x32_bf16 v[104:107], v[48:51], v[8:11], v[104:107]
    ds_read_b128 v[8:11], v60 offset:34112
    s_waitcnt lgkmcnt(3)
    v_mfma_f32_16x16x32_bf16 v[108:111], v[44:47], v[12:15], v[108:111]
    ds_read_b128 v[12:15], v60 offset:34176
    s_waitcnt lgkmcnt(3)
    v_mfma_f32_16x16x32_bf16 v[108:111], v[48:51], v[16:19], v[108:111]
    ds_read_b128 v[16:19], v60 offset:34240
    s_waitcnt lgkmcnt(3)
    v_mfma_f32_16x16x32_bf16 v[108:111], v[52:55], v[4:7], v[108:111]
    ds_read_b128 v[4:7], v60 offset:34304
    s_waitcnt lgkmcnt(3)
    v_mfma_f32_16x16x32_bf16 v[108:111], v[56:59], v[8:11], v[108:111]
    ds_read_b128 v[8:11], v60 offset:34368
    s_waitcnt lgkmcnt(3)
    v_mfma_f32_16x16x32_bf16 v[104:107], v[52:55], v[12:15], v[104:107]
    ds_read_b128 v[12:15], v60 offset:34432
    s_waitcnt lgkmcnt(3)
    v_mfma_f32_16x16x32_bf16 v[104:107], v[56:59], v[16:19], v[104:107]
    ds_read_b128 v[16:19], v60 offset:34496
    s_waitcnt lgkmcnt(3)
    v_mfma_f32_16x16x32_bf16 v[96:99], v[28:31], v[4:7], v[96:99]
    ds_read_b128 v[4:7], v60 offset:34560
    s_waitcnt lgkmcnt(3)
    v_mfma_f32_16x16x32_bf16 v[96:99], v[32:35], v[8:11], v[96:99]
    ds_read_b128 v[8:11], v60 offset:34624
    s_waitcnt lgkmcnt(3)
    v_mfma_f32_16x16x32_bf16 v[100:103], v[52:55], v[12:15], v[100:103]
    ds_read_b128 v[12:15], v60 offset:34688
    s_waitcnt lgkmcnt(3)
    v_mfma_f32_16x16x32_bf16 v[100:103], v[56:59], v[16:19], v[100:103]
    ds_read_b128 v[16:19], v60 offset:34752
    s_waitcnt lgkmcnt(3)
    v_mfma_f32_16x16x32_bf16 v[100:103], v[52:55], v[4:7], v[100:103]
    s_waitcnt lgkmcnt(2)
    v_mfma_f32_16x16x32_bf16 v[100:103], v[56:59], v[8:11], v[100:103]
    s_waitcnt lgkmcnt(1)
    v_mfma_f32_16x16x32_bf16 v[96:99], v[28:31], v[12:15], v[96:99]
    s_waitcnt lgkmcnt(0)
    v_mfma_f32_16x16x32_bf16 v[96:99], v[32:35], v[16:19], v[96:99]
    v_mov_b32 v63, 1
    s_mov_b64 exec, 1
    ds_add_u32 v62, v63 offset:312
    s_mov_b64 exec, -1
    s_cmp_lg_u32 s18, 0
    s_cbranch_scc1 L_skip_38
    s_nop 7
    v_mul_f32 v4, s24, v96
    v_mul_f32 v5, s24, v97
    v_mul_f32 v6, s24, v98
    v_mul_f32 v7, s24, v99
    v_exp_f32 v4, v4
    v_exp_f32 v5, v5
    v_exp_f32 v6, v6
    v_exp_f32 v7, v7
    s_nop 0
    v_add_f32 v4, 1.0, v4
    v_add_f32 v5, 1.0, v5
    v_add_f32 v6, 1.0, v6
    v_add_f32 v7, 1.0, v7
    v_rcp_f32 v4, v4
    v_rcp_f32 v5, v5
    v_rcp_f32 v6, v6
    v_rcp_f32 v7, v7
    s_nop 0
    v_mul_f32 v100, v100, v4
    v_mul_f32 v101, v101, v5
    v_mul_f32 v102, v102, v6
    v_mul_f32 v103, v103, v7
    v_mul_f32 v104, v104, v4
    v_mul_f32 v105, v105, v5
    v_mul_f32 v106, v106, v6
    v_mul_f32 v107, v107, v7
    v_mul_f32 v108, v108, v4
    v_mul_f32 v109, v109, v5
    v_mul_f32 v110, v110, v6
    v_mul_f32 v111, v111, v7
    v_cvt_pk_bf16_f32 v12, v96, v97
    v_cvt_pk_bf16_f32 v13, v98, v99
    ds_write_b64 v1, v[12:13] offset:28672
    v_cvt_pk_bf16_f32 v14, v100, v101
    v_cvt_pk_bf16_f32 v15, v102, v103
    ds_write_b64 v1, v[14:15] offset:28800
    v_cvt_pk_bf16_f32 v16, v104, v105
    v_cvt_pk_bf16_f32 v17, v106, v107
    ds_write_b64 v1, v[16:17] offset:28928
    v_cvt_pk_bf16_f32 v18, v108, v109
    v_cvt_pk_bf16_f32 v19, v110, v111
    ds_write_b64 v1, v[18:19] offset:29056
    ds_append v63 offset:328
    s_mov_b32 s25, 0x400000
    s_waitcnt lgkmcnt(0)
    v_readfirstlane_b32 s22, v63
    s_cmp_ge_u32 s22, 192
    s_cbranch_scc1 L_sg_40
L_sp_39:
    ds_read_b32 v63, v62 offset:328
    s_waitcnt lgkmcnt(0)
    v_readfirstlane_b32 s22, v63
    s_cmp_lt_u32 s22, 256
    s_cbranch_scc1 L_sp_39
L_sg_40:
    ds_read_b128 v[4:7], v2 offset:28672
    ds_read_b128 v[8:11], v2 offset:29728
    s_waitcnt lgkmcnt(1)
    buffer_store_dwordx4 v[4:7], v61, s[8:11], s25 offen sc1
    s_add_u32 s25, s25, 0x40000
    s_waitcnt lgkmcnt(0)
    buffer_store_dwordx4 v[8:11], v61, s[8:11], s25 offen sc1
    s_nop 1
L_skip_38:
    v_mov_b32 v62, 0
L_poll_41:
    ds_read_b32 v63, v62 offset:292
    s_waitcnt lgkmcnt(0)
    v_readfirstlane_b32 s22, v63
    s_cmp_ge_u32 s22, 16
    s_cbranch_scc1 L_go_42
    s_sleep 2
    s_branch L_poll_41
L_go_42:
    ds_read_b128 v[4:7], v60 offset:16896
    ds_read_b128 v[8:11], v60 offset:16960
    ds_read_b128 v[12:15], v60 offset:17024
    ds_read_b128 v[16:19], v60 offset:17088
    s_waitcnt lgkmcnt(3)
    v_mfma_f32_16x16x32_bf16 v[88:91], v[44:47], v[4:7], v[88:91]
    ds_read_b128 v[4:7], v60 offset:17152
    s_waitcnt lgkmcnt(3)
    v_mfma_f32_16x16x32_bf16 v[88:91], v[48:51], v[8:11], v[88:91]
    ds_read_b128 v[8:11], v60 offset:17216
    s_waitcnt lgkmcnt(3)
    v_mfma_f32_16x16x32_bf16 v[92:95], v[44:47], v[12:15], v[92:95]
    ds_read_b128 v[12:15], v60 offset:17280
    s_waitcnt lgkmcnt(3)
    v_mfma_f32_16x16x32_bf16 v[92:95], v[48:51], v[16:19], v[92:95]
    ds_read_b128 v[16:19], v60 offset:17344
    s_waitcnt lgkmcnt(3)
    v_mfma_f32_16x16x32_bf16 v[92:95], v[52:55], v[4:7], v[92:95]
    ds_read_b128 v[4:7], v60 offset:17408
    s_waitcnt lgkmcnt(3)
    v_mfma_f32_16x16x32_bf16 v[92:95], v[56:59], v[8:11], v[92:95]
    ds_read_b128 v[8:11], v60 offset:17472
    s_waitcnt lgkmcnt(3)
    v_mfma_f32_16x16x32_bf16 v[88:91], v[52:55], v[12:15], v[88:91]
    ds_read_b128 v[12:15], v60 offset:17536
    s_waitcnt lgkmcnt(3)
    v_mfma_f32_16x16x32_bf16 v[88:91], v[56:59], v[16:19], v[88:91]
    ds_read_b128 v[16:19], v60 offset:17600
    s_waitcnt lgkmcnt(3)
    v_mfma_f32_16x16x32_bf16 v[80:83], v[28:31], v[4:7], v[80:83]
    ds_read_b128 v[4:7], v60 offset:17664
    s_waitcnt lgkmcnt(3)
    v_mfma_f32_16x16x32_bf16 v[80:83], v[32:35], v[8:11], v[80:83]
    ds_read_b128 v[8:11], v60 offset:17728
    s_waitcnt lgkmcnt(3)
    v_mfma_f32_16x16x32_bf16 v[84:87], v[52:55], v[12:15], v[84:87]
    ds_read_b128 v[12:15], v60 offset:17792
    s_waitcnt lgkmcnt(3)
    v_mfma_f32_16x16x32_bf16 v[84:87], v[56:59], v[16:19], v[84:87]
    ds_read_b128 v[16:19], v60 offset:17856
    s_waitcnt lgkmcnt(3)
    v_mfma_f32_16x16x32_bf16 v[84:87], v[52:55], v[4:7], v[84:87]
    s_waitcnt lgkmcnt(2)
    v_mfma_f32_16x16x32_bf16 v[84:87], v[56:59], v[8:11], v[84:87]
    s_waitcnt lgkmcnt(1)
    v_mfma_f32_16x16x32_bf16 v[80:83], v[28:31], v[12:15], v[80:83]
    s_waitcnt lgkmcnt(0)
    v_mfma_f32_16x16x32_bf16 v[80:83], v[32:35], v[16:19], v[80:83]
    s_cmp_lg_u32 s18, 0
    s_cbranch_scc1 L_skip_43
    s_nop 7
    v_mul_f32 v4, s24, v80
    v_mul_f32 v5, s24, v81
    v_mul_f32 v6, s24, v82
    v_mul_f32 v7, s24, v83
    v_exp_f32 v4, v4
    v_exp_f32 v5, v5
    v_exp_f32 v6, v6
    v_exp_f32 v7, v7
    s_nop 0
    v_add_f32 v4, 1.0, v4
    v_add_f32 v5, 1.0, v5
    v_add_f32 v6, 1.0, v6
    v_add_f32 v7, 1.0, v7
    v_rcp_f32 v4, v4
    v_rcp_f32 v5, v5
    v_rcp_f32 v6, v6
    v_rcp_f32 v7, v7
    s_nop 0
    v_mul_f32 v84, v84, v4
    v_mul_f32 v85, v85, v5
    v_mul_f32 v86, v86, v6
    v_mul_f32 v87, v87, v7
    v_mul_f32 v88, v88, v4
    v_mul_f32 v89, v89, v5
    v_mul_f32 v90, v90, v6
    v_mul_f32 v91, v91, v7
    v_mul_f32 v92, v92, v4
    v_mul_f32 v93, v93, v5
    v_mul_f32 v94, v94, v6
    v_mul_f32 v95, v95, v7
    v_cvt_pk_bf16_f32 v12, v80, v81
    v_cvt_pk_bf16_f32 v13, v82, v83
    ds_write_b64 v1, v[12:13] offset:14336
    v_cvt_pk_bf16_f32 v14, v84, v85
    v_cvt_pk_bf16_f32 v15, v86, v87
    ds_write_b64 v1, v[14:15] offset:14464
    v_cvt_pk_bf16_f32 v16, v88, v89
    v_cvt_pk_bf16_f32 v17, v90, v91
    ds_write_b64 v1, v[16:17] offset:14592
    v_cvt_pk_bf16_f32 v18, v92, v93
    v_cvt_pk_bf16_f32 v19, v94, v95
    ds_write_b64 v1, v[18:19] offset:14720
    ds_append v63 offset:324
    s_mov_b32 s25, 0x200000
    s_waitcnt lgkmcnt(0)
    v_readfirstlane_b32 s22, v63
    s_cmp_ge_u32 s22, 192
    s_cbranch_scc1 L_sg_45
L_sp_44:
    ds_read_b32 v63, v62 offset:324
    s_waitcnt lgkmcnt(0)
    v_readfirstlane_b32 s22, v63
    s_cmp_lt_u32 s22, 256
    s_cbranch_scc1 L_sp_44
L_sg_45:
    ds_read_b128 v[4:7], v2 offset:14336
    ds_read_b128 v[8:11], v2 offset:15392
    s_waitcnt lgkmcnt(1)
    buffer_store_dwordx4 v[4:7], v61, s[8:11], s25 offen sc1
    s_add_u32 s25, s25, 0x40000
    s_waitcnt lgkmcnt(0)
    buffer_store_dwordx4 v[8:11], v61, s[8:11], s25 offen sc1
    s_nop 1
L_skip_43:
    s_cmp_lg_u32 s18, 0
    s_cbranch_scc1 L_slow_49
    v_mov_b32 v62, 0
    s_mov_b32 s25, 0x40000
L_fp_50:
    ds_read_b32 v63, v62 offset:288
    ds_read_b128 v[4:7], v60 offset:512
    ds_read_b128 v[8:11], v60 offset:576
    ds_read_b128 v[12:15], v60 offset:896
    ds_read_b128 v[16:19], v60 offset:960
    s_waitcnt lgkmcnt(4)
    v_cmp_gt_u32 vcc, 16, v63
    s_cbranch_vccnz L_fp_50
    ds_read_b128 v[80:83], v60 offset:640
    ds_read_b128 v[84:87], v60 offset:704
    ds_read_b128 v[88:91], v60 offset:768
    ds_read_b128 v[92:95], v60 offset:832
    s_waitcnt lgkmcnt(7)
    v_mfma_f32_16x16x32_bf16 v[64:67], v[28:31], v[4:7], v[64:67]
    ds_read_b128 v[96:99], v60 offset:0
    s_waitcnt lgkmcnt(7)
    v_mfma_f32_16x16x32_bf16 v[64:67], v[32:35], v[8:11], v[64:67]
    ds_read_b128 v[100:103], v60 offset:64
    s_waitcnt lgkmcnt(7)
    v_mfma_f32_16x16x32_bf16 v[64:67], v[28:31], v[12:15], v[64:67]
    ds_read_b128 v[104:107], v60 offset:384
    s_waitcnt lgkmcnt(7)
    v_mfma_f32_16x16x32_bf16 v[64:67], v[32:35], v[16:19], v[64:67]
    ds_read_b128 v[108:111], v60 offset:448
    s_waitcnt lgkmcnt(7)
    v_mfma_f32_16x16x32_bf16 v[68:71], v[52:55], v[80:83], v[68:71]
    ds_read_b128 v[112:115], v60 offset:128
    s_waitcnt lgkmcnt(7)
    v_mfma_f32_16x16x32_bf16 v[68:71], v[56:59], v[84:87], v[68:71]
    ds_read_b128 v[116:119], v60 offset:192
    s_nop 3
    v_mul_f32 v4, s24, v64
    v_mul_f32 v5, s24, v65
    s_waitcnt lgkmcnt(7)
    v_mfma_f32_16x16x32_bf16 v[68:71], v[52:55], v[88:91], v[68:71]
    ds_read_b128 v[120:123], v60 offset:256
    v_mul_f32 v6, s24, v66
    v_mul_f32 v7, s24, v67
    v_exp_f32 v4, v4
    s_waitcnt lgkmcnt(7)
    v_mfma_f32_16x16x32_bf16 v[68:71], v[56:59], v[92:95], v[68:71]
    ds_read_b128 v[124:127], v60 offset:320
    v_exp_f32 v5, v5
    v_exp_f32 v6, v6
    s_waitcnt lgkmcnt(7)
    v_mfma_f32_16x16x32_bf16 v[72:75], v[44:47], v[96:99], v[72:75]
    v_exp_f32 v7, v7
    v_add_f32 v4, 1.0, v4
    v_add_f32 v5, 1.0, v5
    s_waitcnt lgkmcnt(6)
    v_mfma_f32_16x16x32_bf16 v[72:75], v[48:51], v[100:103], v[72:75]
    v_add_f32 v6, 1.0, v6
    v_add_f32 v7, 1.0, v7
    v_rcp_f32 v4, v4
    s_waitcnt lgkmcnt(5)
    v_mfma_f32_16x16x32_bf16 v[72:75], v[52:55], v[104:107], v[72:75]
    v_rcp_f32 v5, v5
    v_rcp_f32 v6, v6
    s_waitcnt lgkmcnt(4)
    v_mfma_f32_16x16x32_bf16 v[72:75], v[56:59], v[108:111], v[72:75]
    v_rcp_f32 v7, v7
    v_cvt_pk_bf16_f32 v8, v64, v65
    v_cvt_pk_bf16_f32 v9, v66, v67
    s_waitcnt lgkmcnt(3)
    v_mfma_f32_16x16x32_bf16 v[76:79], v[44:47], v[112:115], v[76:79]
    ds_write_b64 v1, v[8:9] offset:0
    v_mul_f32 v68, v68, v4
    v_mul_f32 v69, v69, v5
    v_mul_f32 v70, v70, v6
    s_waitcnt lgkmcnt(3)
    v_mfma_f32_16x16x32_bf16 v[76:79], v[48:51], v[116:119], v[76:79]
    v_mul_f32 v71, v71, v7
    v_cvt_pk_bf16_f32 v10, v68, v69
    v_cvt_pk_bf16_f32 v11, v70, v71
    ds_write_b64 v1, v[10:11] offset:128
    s_waitcnt lgkmcnt(3)
    v_mfma_f32_16x16x32_bf16 v[76:79], v[52:55], v[120:123], v[76:79]
    v_mul_f32 v72, v72, v4
    v_mul_f32 v73, v73, v5
    v_mul_f32 v74, v74, v6
    v_mul_f32 v75, v75, v7
    s_waitcnt lgkmcnt(2)
    v_mfma_f32_16x16x32_bf16 v[76:79], v[56:59], v[124:127], v[76:79]
    v_cvt_pk_bf16_f32 v12, v72, v73
    v_cvt_pk_bf16_f32 v13, v74, v75
    ds_write_b64 v1, v[12:13] offset:256
    s_nop 4
    v_mul_f32 v76, v76, v4
    v_mul_f32 v77, v77, v5
    v_mul_f32 v78, v78, v6
    v_mul_f32 v79, v79, v7
    v_cvt_pk_bf16_f32 v14, v76, v77
    v_cvt_pk_bf16_f32 v15, v78, v79
    ds_write_b64 v1, v[14:15] offset:384
    ds_append v63 offset:320
L_sp_51:
    ds_read_b32 v63, v62 offset:320
    ds_read_b128 v[4:7], v2 offset:0
    ds_read_b128 v[8:11], v2 offset:1056
    s_waitcnt lgkmcnt(2)
    v_cmp_gt_u32 vcc, 0x100, v63
    s_cbranch_vccnz L_sp_51
    s_waitcnt lgkmcnt(1)
    buffer_store_dwordx4 v[4:7], v61, s[8:11], 0 offen sc1
    s_waitcnt lgkmcnt(0)
    buffer_store_dwordx4 v[8:11], v61, s[8:11], s25 offen sc1
    s_branch L_k2_out
L_slow_49:
    v_mov_b32 v62, 0
L_poll_46:
    ds_read_b32 v63, v62 offset:288
    s_waitcnt lgkmcnt(0)
    v_readfirstlane_b32 s22, v63
    s_cmp_ge_u32 s22, 16
    s_cbranch_scc1 L_go_47
    s_sleep 2
    s_branch L_poll_46
L_go_47:
    ds_read_b128 v[4:7], v60 offset:0
    ds_read_b128 v[8:11], v60 offset:64
    ds_read_b128 v[12:15], v60 offset:128
    ds_read_b128 v[16:19], v60 offset:192
    s_waitcnt lgkmcnt(3)
    v_mfma_f32_16x16x32_bf16 v[72:75], v[44:47], v[4:7], v[72:75]
    ds_read_b128 v[4:7], v60 offset:256
    s_waitcnt lgkmcnt(3)
    v_mfma_f32_16x16x32_bf16 v[72:75], v[48:51], v[8:11], v[72:75]
    ds_read_b128 v[8:11], v60 offset:320
    s_waitcnt lgkmcnt(3)
    v_mfma_f32_16x16x32_bf16 v[76:79], v[44:47], v[12:15], v[76:79]
    ds_read_b128 v[12:15], v60 offset:384
    s_waitcnt lgkmcnt(3)
    v_mfma_f32_16x16x32_bf16 v[76:79], v[48:51], v[16:19], v[76:79]
    ds_read_b128 v[16:19], v60 offset:448
    s_waitcnt lgkmcnt(3)
    v_mfma_f32_16x16x32_bf16 v[76:79], v[52:55], v[4:7], v[76:79]
    ds_read_b128 v[4:7], v60 offset:512
    s_waitcnt lgkmcnt(3)
    v_mfma_f32_16x16x32_bf16 v[76:79], v[56:59], v[8:11], v[76:79]
    ds_read_b128 v[8:11], v60 offset:576
    s_waitcnt lgkmcnt(3)
    v_mfma_f32_16x16x32_bf16 v[72:75], v[52:55], v[12:15], v[72:75]
    ds_read_b128 v[12:15], v60 offset:640
    s_waitcnt lgkmcnt(3)
    v_mfma_f32_16x16x32_bf16 v[72:75], v[56:59], v[16:19], v[72:75]
    ds_read_b128 v[16:19], v60 offset:704
    s_waitcnt lgkmcnt(3)
    v_mfma_f32_16x16x32_bf16 v[64:67], v[28:31], v[4:7], v[64:67]
    ds_read_b128 v[4:7], v60 offset:768
    s_waitcnt lgkmcnt(3)
    v_mfma_f32_16x16x32_bf16 v[64:67], v[32:35], v[8:11], v[64:67]
    ds_read_b128 v[8:11], v60 offset:832
    s_waitcnt lgkmcnt(3)
    v_mfma_f32_16x16x32_bf16 v[68:71], v[52:55], v[12:15], v[68:71]
    ds_read_b128 v[12:15], v60 offset:896
    s_waitcnt lgkmcnt(3)
    v_mfma_f32_16x16x32_bf16 v[68:71], v[56:59], v[16:19], v[68:71]
    ds_read_b128 v[16:19], v60 offset:960
    s_waitcnt lgkmcnt(3)
    v_mfma_f32_16x16x32_bf16 v[68:71], v[52:55], v[4:7], v[68:71]
    s_waitcnt lgkmcnt(2)
    v_mfma_f32_16x16x32_bf16 v[68:71], v[56:59], v[8:11], v[68:71]
    s_waitcnt lgkmcnt(1)
    v_mfma_f32_16x16x32_bf16 v[64:67], v[28:31], v[12:15], v[64:67]
    s_waitcnt lgkmcnt(0)
    v_mfma_f32_16x16x32_bf16 v[64:67], v[32:35], v[16:19], v[64:67]
    s_cmp_lg_u32 s18, 0
    s_cbranch_scc1 L_skip_48
    s_nop 7
    v_mul_f32 v4, s24, v64
    v_mul_f32 v5, s24, v65
    v_mul_f32 v6, s24, v66
    v_mul_f32 v7, s24, v67
    v_exp_f32 v4, v4
    v_exp_f32 v5, v5
    v_exp_f32 v6, v6
    v_exp_f32 v7, v7
    s_nop 0
    v_add_f32 v4, 1.0, v4
    v_add_f32 v5, 1.0, v5
    v_add_f32 v6, 1.0, v6
    v_add_f32 v7, 1.0, v7
    v_rcp_f32 v4, v4
    v_rcp_f32 v5, v5
    v_rcp_f32 v6, v6
    v_rcp_f32 v7, v7
    s_nop 0
    v_mul_f32 v68, v68, v4
    v_mul_f32 v69, v69, v5
    v_mul_f32 v70, v70, v6
    v_mul_f32 v71, v71, v7
    v_mul_f32 v72, v72, v4
    v_mul_f32 v73, v73, v5
    v_mul_f32 v74, v74, v6
    v_mul_f32 v75, v75, v7
    v_mul_f32 v76, v76, v4
    v_mul_f32 v77, v77, v5
    v_mul_f32 v78, v78, v6
    v_mul_f32 v79, v79, v7
    v_cvt_pk_bf16_f32 v12, v64, v65
    v_cvt_pk_bf16_f32 v13, v66, v67
    ds_write_b64 v1, v[12:13] offset:0
    v_cvt_pk_bf16_f32 v14, v68, v69
    v_cvt_pk_bf16_f32 v15, v70, v71
    ds_write_b64 v1, v[14:15] offset:128
    v_cvt_pk_bf16_f32 v16, v72, v73
    v_cvt_pk_bf16_f32 v17, v74, v75
    ds_write_b64 v1, v[16:17] offset:256
    v_cvt_pk_bf16_f32 v18, v76, v77
    v_cvt_pk_bf16_f32 v19, v78, v79
    ds_write_b64 v1, v[18:19] offset:384
    ds_append v63 offset:320
    s_mov_b32 s25, 0x0
    s_waitcnt lgkmcnt(0)
    v_readfirstlane_b32 s22, v63
    s_cmp_ge_u32 s22, 192
    s_cbranch_scc1 L_sg_54
L_sp_53:
    ds_read_b32 v63, v62 offset:320
    s_waitcnt lgkmcnt(0)
    v_readfirstlane_b32 s22, v63
    s_cmp_lt_u32 s22, 256
    s_cbranch_scc1 L_sp_53
L_sg_54:
    ds_read_b128 v[4:7], v2 offset:0
    ds_read_b128 v[8:11], v2 offset:1056
    s_waitcnt lgkmcnt(1)
    buffer_store_dwordx4 v[4:7], v61, s[8:11], s25 offen sc1
    s_add_u32 s25, s25, 0x40000
    s_waitcnt lgkmcnt(0)
    buffer_store_dwordx4 v[8:11], v61, s[8:11], s25 offen sc1
    s_nop 1
L_skip_48:
    s_cmp_lg_u32 s18, 0
    s_cbranch_scc1 L_k2_next
L_k2_out:
L_k2_end:
    s_endpgm
L_far_end:
L_k2_nine:
    buffer_load_dwordx4 v[60:63], v4, s[12:15], 0 offen offset:512 sc1
    v_lshrrev_b32 v6, 4, v4
    s_mov_b32 s22, 0xc80000
    buffer_load_ubyte v15, v6, s[12:15], s22 offen offset:32 sc1
    s_waitcnt vmcnt(0)
    v_and_b32 v15, s23, v15
    ds_add_rtn_u32 v15, v15, v19 offset:0
    v_cmpx_lt_i32 vcc, 36, v5
    v_mov_b32 v16, 56450
    v_mov_b32 v17, 0
    ds_write_b32 v17, v16 offset:252
    s_branch L_k2_cnt
L_k2_over:
    s_cmp_eq_u32 s20, 0
    s_cbranch_scc1 L_k2_redo
    s_mov_b32 s19, 1
    s_mov_b32 s18, 1
    v_min_u32 v13, 28, v13
    s_cmp_ge_u32 s16, 12
    s_branch L_k2_go
L_k2_next:
    s_mov_b32 s28, 0
    s_cmp_lg_u32 s19, 0
    s_cselect_b32 s22, 0, 36
    s_add_u32 s17, s17, s22
L_k2_redo:
    s_mov_b32 s20, 1
    v_mbcnt_lo_u32_b32 v0, -1, 0
    v_mbcnt_hi_u32_b32 v0, -1, v0
    v_lshl_add_u32 v0, s16, 6, v0
    v_lshlrev_b32 v3, 2, v0
    v_add_u32 v3, 157088, v3
    ds_read_b32 v2, v3
    v_lshrrev_b32 v4, 2, v0
    v_and_b32 v15, 3, v0
    v_lshlrev_b32 v5, 13, v4
    v_lshl_add_u32 v5, v15, 3, v5
    s_lshl_b32 s25, s3, 5
    s_add_u32 s25, s25, 0x1000000
    buffer_load_dwordx2 v[16:17], v5, s[12:15], s25 offen sc1
    v_lshlrev_b32 v1, 4, v0
    s_load_dwordx4 s[48:51], s[0:1], 48
    s_waitcnt vmcnt(0) lgkmcnt(0)
    s_barrier
    s_cmp_ge_u32 s16, 10
    s_cbranch_scc1 L_nows_55
    s_cmp_ge_u32 s16, 4
    s_cselect_b32 s48, s50, s48
    s_cselect_b32 s49, s51, s49
    s_cselect_b32 s22, 4*4096, 0
    s_mul_i32 s40, s16, 3072
    s_sub_u32 s22, s40, s22
    s_lshl_b32 s40, s16, 10
    s_add_u32 m0, s40, 105344
    v_add_u32 v60, s22, v1
    global_load_lds_dwordx4 v60, s[48:49] offset:0
    s_add_u32 m0, m0, 11776
    s_nop 0
    global_load_lds_dwordx4 v60, s[48:49] offset:1024
    s_add_u32 m0, m0, 11776
    s_nop 0
    global_load_lds_dwordx4 v60, s[48:49] offset:2048
    s_add_u32 m0, m0, 11776
    s_nop 0
    global_load_lds_dwordx4 v60, s[48:49] offset:3072
L_nows_55:
    v_add_u32 v52, 61440, v1
    v_mov_b64 v[40:41], 0
    v_mov_b64 v[42:43], 0
    v_mov_b32 v44, 2.0
    ds_write_b128 v52, v[40:43]
    v_mov_b32 v45, 2.0
    v_mov_b32 v46, 2.0
    v_mov_b32 v47, 2.0
    ds_write_b128 v52, v[40:43] offset:16384
    ds_write_b128 v1, v[44:47] offset:17408
    ds_write_b128 v1, v[44:47] offset:33792
    v_cmpx_gt_u32 vcc, 696, v0
    ds_write_b128 v52, v[40:43] offset:32768
    ds_write_b128 v1, v[44:47] offset:50176
    s_mov_b64 exec, -1
    s_cmp_ge_u32 s16, 2
    s_cbranch_scc1 L_noctl_56
    s_cmp_eq_u32 s16, 0
    s_cselect_b32 s22, 896, 0
    v_cmp_eq_u32 vcc, 64, v0
    v_lshlrev_b32 v52, 2, v0
    v_mul_u32_u24 v53, s22, v0
    v_mov_b32 v48, 768
    v_cndmask_b32 v53, v53, v48, vcc
    ds_write_b32 v52, v53
L_noctl_56:
    v_mul_u32_u24 v4, 3200, v4
    v_lshlrev_b32 v6, 3, v15
    s_mov_b32 s23, 0x16100600
    v_bfe_u32 v6, s23, v6, 8
    v_add_u32 v15, s17, v15
    v_add_u32 v4, v4, v15
    s_movk_i32 s23, 0xfc
    v_mov_b32 v18, 2
    s_waitcnt vmcnt(0) lgkmcnt(0)
    s_barrier
    v_bfe_u32 v5, v17, 16, 6
    v_lshlrev_b32 v6, v6, v5
    v_lshlrev_b32 v7, 2, v16
    v_and_b32 v7, s23, v7
    v_or_b32_dpp v6, v6, v6 quad_perm:[1,0,3,2] row_mask:0xf bank_mask:0xf
    v_lshrrev_b32 v8, 4, v16
    v_and_b32 v8, s23, v8
    v_or_b32_dpp v6, v6, v6 quad_perm:[2,3,0,1] row_mask:0xf bank_mask:0xf
    v_add_u32_sdwa v4, v4, v6 dst_sel:DWORD dst_unused:UNUSED_PAD src0_sel:DWORD src1_sel:WORD_0
    v_sub_u32_sdwa v5, v6, v15 dst_sel:DWORD dst_unused:UNUSED_PAD src0_sel:WORD_1 src1_sel:DWORD
    v_lshrrev_b32 v9, 10, v16
    v_and_b32 v9, s23, v9
    v_lshrrev_b32 v10, 16, v16
    v_and_b32 v10, s23, v10
    v_lshrrev_b32 v11, 22, v16
    v_and_b32 v11, s23, v11
    v_alignbit_b32 v12, v17, v16, 28
    v_and_b32 v12, s23, v12
    v_lshrrev_b32 v13, 2, v17
    v_and_b32 v13, s23, v13
    v_lshrrev_b32 v14, 8, v17
    v_and_b32 v14, s23, v14
    s_mov_b32 s22, 0xc80000
    buffer_load_ubyte v15, v4, s[12:15], s22 offen offset:32 sc1
    s_cmp_eq_u32 s17, 0
    s_cbranch_scc1 L_k2_c1
    buffer_load_ubyte v7, v4, s[12:15], s22 offen offset:0 sc1
    buffer_load_ubyte v8, v4, s[12:15], s22 offen offset:4 sc1
    buffer_load_ubyte v9, v4, s[12:15], s22 offen offset:8 sc1
    buffer_load_ubyte v10, v4, s[12:15], s22 offen offset:12 sc1
    buffer_load_ubyte v11, v4, s[12:15], s22 offen offset:16 sc1
    buffer_load_ubyte v12, v4, s[12:15], s22 offen offset:20 sc1
    buffer_load_ubyte v13, v4, s[12:15], s22 offen offset:24 sc1
    buffer_load_ubyte v14, v4, s[12:15], s22 offen offset:28 sc1
L_k2_c1:
    s_cmp_lg_u32 s19, 0
    s_cbranch_scc1 L_k2_c2
    v_add_u32 v2, 3, v5
    v_ashrrev_i32 v2, 2, v2
    v_med3_i32 v2, v2, 0, 9
    v_bfm_b32 v2, v2, 0
L_k2_c2:
    v_bfrev_b32 v1, v2
    v_add_co_u32 v1, s[40:41], v1, v1
    v_add_co_u32 v1, s[42:43], v1, v1
    v_add_co_u32 v1, s[44:45], v1, v1
    v_add_co_u32 v1, s[46:47], v1, v1
    v_add_co_u32 v1, s[48:49], v1, v1
    v_add_co_u32 v1, s[50:51], v1, v1
    v_add_co_u32 v1, s[52:53], v1, v1
    v_add_co_u32 v1, s[54:55], v1, v1
    v_add_co_u32 v1, s[56:57], v1, v1
    s_waitcnt vmcnt(0)
    v_lshlrev_b32 v4, 4, v4
    s_mov_b64 exec, s[40:41]
    v_and_b32 v7, s23, v7
    buffer_load_dwordx4 v[28:31], v4, s[12:15], 0 offen offset:0 sc1
    ds_add_rtn_u32 v19, v7, v18 offset:0
    s_mov_b64 exec, s[42:43]
    v_and_b32 v8, s23, v8
    buffer_load_dwordx4 v[32:35], v4, s[12:15], 0 offen offset:64 sc1
    ds_add_rtn_u32 v20, v8, v18 offset:0
    s_mov_b64 exec, s[44:45]
    v_and_b32 v9, s23, v9
    buffer_load_dwordx4 v[36:39], v4, s[12:15], 0 offen offset:128 sc1
    ds_add_rtn_u32 v21, v9, v18 offset:0
    s_mov_b64 exec, s[46:47]
    v_and_b32 v10, s23, v10
    buffer_load_dwordx4 v[40:43], v4, s[12:15], 0 offen offset:192 sc1
    ds_add_rtn_u32 v22, v10, v18 offset:0
    s_mov_b64 exec, s[48:49]
    v_and_b32 v11, s23, v11
    buffer_load_dwordx4 v[44:47], v4, s[12:15], 0 offen offset:256 sc1
    ds_add_rtn_u32 v23, v11, v18 offset:0
    s_mov_b64 exec, s[50:51]
    v_and_b32 v12, s23, v12
    buffer_load_dwordx4 v[48:51], v4, s[12:15], 0 offen offset:320 sc1
    ds_add_rtn_u32 v24, v12, v18 offset:0
    s_mov_b64 exec, s[52:53]
    v_and_b32 v13, s23, v13
    buffer_load_dwordx4 v[52:55], v4, s[12:15], 0 offen offset:384 sc1
    ds_add_rtn_u32 v25, v13, v18 offset:0
    s_mov_b64 exec, s[54:55]
    v_and_b32 v14, s23, v14
    buffer_load_dwordx4 v[56:59], v4, s[12:15], 0 offen offset:448 sc1
    ds_add_rtn_u32 v26, v14, v18 offset:0
    s_mov_b64 exec, s[56:57]
    v_and_b32 v15, s23, v15
    buffer_load_dwordx4 v[60:63], v4, s[12:15], 0 offen offset:512 sc1
    ds_add_rtn_u32 v27, v15, v18 offset:0
    s_mov_b64 exec, -1
    v_cmpx_lt_i32 vcc, 36, v5
    v_mov_b32 v16, 56450
    v_mov_b32 v17, 0
    ds_write_b32 v17, v16 offset:252
    s_waitcnt vmcnt(0) lgkmcnt(0)
    s_mov_b64 exec, s[40:41]
    v_mul_u32_u24 v4, 224, v7
    v_sub_u32 v4, v19, v4
    v_cmpx_gt_u32 vcc, 224, v4
    v_xor_b32 v2, 1, v2
    v_and_b32 v4, 6, v19
    v_mad_u32_u24 v19, v4, s21, v19
    ds_write_b64 v19, v[30:31] offset:17408
    ds_write_b64 v19, v[28:29] offset:61440
    s_mov_b64 exec, s[42:43]
    v_mul_u32_u24 v4, 224, v8
    v_sub_u32 v4, v20, v4
    v_cmpx_gt_u32 vcc, 224, v4
    v_xor_b32 v2, 2, v2
    v_and_b32 v4, 6, v20
    v_mad_u32_u24 v20, v4, s21, v20
    ds_write_b64 v20, v[34:35] offset:17408
    ds_write_b64 v20, v[32:33] offset:61440
    s_mov_b64 exec, s[44:45]
    v_mul_u32_u24 v4, 224, v9
    v_sub_u32 v4, v21, v4
    v_cmpx_gt_u32 vcc, 224, v4
    v_xor_b32 v2, 4, v2
    v_and_b32 v4, 6, v21
    v_mad_u32_u24 v21, v4, s21, v21
    ds_write_b64 v21, v[38:39] offset:17408
    ds_write_b64 v21, v[36:37] offset:61440
    s_mov_b64 exec, s[46:47]
    v_mul_u32_u24 v4, 224, v10
    v_sub_u32 v4, v22, v4
    v_cmpx_gt_u32 vcc, 224, v4
    v_xor_b32 v2, 8, v2
    v_and_b32 v4, 6, v22
    v_mad_u32_u24 v22, v4, s21, v22
    ds_write_b64 v22, v[42:43] offset:17408
    ds_write_b64 v22, v[40:41] offset:61440
    s_mov_b64 exec, s[48:49]
    v_mul_u32_u24 v4, 224, v11
    v_sub_u32 v4, v23, v4
    v_cmpx_gt_u32 vcc, 224, v4
    v_xor_b32 v2, 16, v2
    v_and_b32 v4, 6, v23
    v_mad_u32_u24 v23, v4, s21, v23
    ds_write_b64 v23, v[46:47] offset:17408
    ds_write_b64 v23, v[44:45] offset:61440
    s_mov_b64 exec, s[50:51]
    v_mul_u32_u24 v4, 224, v12
    v_sub_u32 v4, v24, v4
    v_cmpx_gt_u32 vcc, 224, v4
    v_xor_b32 v2, 32, v2
    v_and_b32 v4, 6, v24
    v_mad_u32_u24 v24, v4, s21, v24
    ds_write_b64 v24, v[50:51] offset:17408
    ds_write_b64 v24, v[48:49] offset:61440
    s_mov_b64 exec, s[52:53]
    v_mul_u32_u24 v4, 224, v13
    v_sub_u32 v4, v25, v4
    v_cmpx_gt_u32 vcc, 224, v4
    v_xor_b32 v2, 64, v2
    v_and_b32 v4, 6, v25
    v_mad_u32_u24 v25, v4, s21, v25
    ds_write_b64 v25, v[54:55] offset:17408
    ds_write_b64 v25, v[52:53] offset:61440
    s_mov_b64 exec, s[54:55]
    v_mul_u32_u24 v4, 224, v14
    v_sub_u32 v4, v26, v4
    v_cmpx_gt_u32 vcc, 224, v4
    v_xor_b32 v2, 128, v2
    v_and_b32 v4, 6, v26
    v_mad_u32_u24 v26, v4, s21, v26
    ds_write_b64 v26, v[58:59] offset:17408
    ds_write_b64 v26, v[56:57] offset:61440
    s_mov_b64 exec, s[56:57]
    v_mul_u32_u24 v4, 224, v15
    v_sub_u32 v4, v27, v4
    v_cmpx_gt_u32 vcc, 224, v4
    v_xor_b32 v2, 256, v2
    v_and_b32 v4, 6, v27
    v_mad_u32_u24 v27, v4, s21, v27
    ds_write_b64 v27, v[62:63] offset:17408
    ds_write_b64 v27, v[60:61] offset:61440
    s_mov_b64 exec, -1
    ds_write_b32 v3, v2
    v_bfe_u32 v9, v0, 4, 2
    v_bfe_u32 v10, v0, 2, 2
    v_and_b32 v11, 3, v0
    v_lshlrev_b32 v27, 4, v0
    v_and_b32 v1, 0xf0, v27
    v_and_b32 v27, 0x3f0, v27
    v_cmp_eq_u32 vcc, 3, v10
    v_add_u32 v11, 2176, v11
    v_mul_u32_u24 v2, 0xe000e0, v9
    v_addc_co_u32 v11, vcc, v11, v11, vcc
    v_lshl_add_u32 v2, v10, 3, v2
    s_sub_u32 s22, 48, s16
    s_mul_i32 s22, s22, 896
    v_lshl_add_u32 v2, v11, 18, v2
    v_sub_u32 v8, 48, v0
    v_add_u32_sdwa v3, s22, v2 dst_sel:DWORD dst_unused:UNUSED_PAD src0_sel:DWORD src1_sel:WORD_1
    v_and_b32 v8, 63, v8
    s_movk_i32 s22, 896
    v_lshlrev_b32 v24, 2, v8
    v_mad_u32_u24 v25, v8, s22, -6
    v_mul_u32_u24 v26, 0xe0001, v8
    v_lshl_add_u32 v26, v26, 6, 40
    v_lshlrev_b32 v10, 3, v10
    s_mov_b32 s38, 0x0c0e0c08
    v_bfe_u32 v22, s38, v10, 8
    v_mov_b32 v23, 0
    v_mul_u32_u24 v22, 0x101, v22
    s_movk_i32 s38, 0x3f80
    v_or_b32 v22, 0x100, v22
    v_lshlrev_b64 v[22:23], v1, v[22:23]
    v_xor_b32 v22, 0x0c0c0c0c, v22
    v_xor_b32 v23, 0x0c0c0c0c, v23
    s_mov_b32 m0, 0
    s_mov_b32 s29, 0x400008
    s_movk_i32 s30, 3136
    s_mov_b32 s19, 0
    s_mov_b32 s36, -1
    s_branch L_k2_fin
L_k2_giveup:
    v_mov_b64 v[16:17], 0
    s_branch L_k2_ent
L_k1_big:
    s_mul_i32 s39, s2, 3200
    s_add_u32 s39, s39, 0xc7e648
    v_add_u32 v44, v56, v32
    v_cmp_le_u32 vcc, 32, v32
    v_lshrrev_b32 v4, 8, v4
    v_lshlrev_b32 v4, 2, v4
    s_mov_b64 exec, vcc
    buffer_store_byte v4, v44, s[12:15], s39 offen sc1
    s_mov_b64 exec, s[40:41]
    v_add_u32 v44, v57, v33
    v_cmp_le_u32 vcc, 32, v33
    v_lshrrev_b32 v5, 8, v5
    v_lshlrev_b32 v5, 2, v5
    s_mov_b64 exec, vcc
    buffer_store_byte v5, v44, s[12:15], s39 offen sc1
    s_mov_b64 exec, s[40:41]
    v_add_u32 v44, v58, v34
    v_cmp_le_u32 vcc, 32, v34
    v_lshrrev_b32 v6, 8, v6
    v_lshlrev_b32 v6, 2, v6
    s_mov_b64 exec, vcc
    buffer_store_byte v6, v44, s[12:15], s39 offen sc1
    s_mov_b64 exec, s[40:41]
    v_add_u32 v44, v59, v35
    v_cmp_le_u32 vcc, 32, v35
    v_lshrrev_b32 v7, 8, v7
    v_lshlrev_b32 v7, 2, v7
    s_mov_b64 exec, vcc
    buffer_store_byte v7, v44, s[12:15], s39 offen sc1
    s_mov_b64 exec, s[40:41]
    s_waitcnt vmcnt(0)
    s_branch L_k1_bigdone
L_k2_pre:
    s_cmp_lg_u32 s16, 8
    s_cbranch_scc1 L_k2_preok
    s_mov_b64 exec, 15
L_pre_57:
    s_sleep 1
    buffer_load_dwordx2 v[16:17], v5, s[12:15], s25 offen sc1
    s_sub_u32 s24, s24, 1
    s_waitcnt vmcnt(0)
    v_xor_b32 v7, v17, v18
    v_cmp_le_u32 vcc, s22, v7
    s_cbranch_scc1 L_k2_pre2
    s_cbranch_vccnz L_pre_57
L_k2_pre2:
    s_mov_b64 exec, -1
    s_mov_b32 s24, 0x40000
    s_branch L_k2_preok
L_code_end:
.if L_code_end-L_k1_pc1 < 16384
.error "code shorter than the range asked for"
.endif
.section .rodata,"a"
.p2align 6
.amdhsa_kernel standalone__tensor_product_equiv_equiformer__graph_kernel
  .amdhsa_next_free_vgpr 128
  .amdhsa_next_free_sgpr 102
  .amdhsa_accum_offset 128
  .amdhsa_group_segment_fixed_size 0
  .amdhsa_kernarg_size 96
  .amdhsa_user_sgpr_count 2
  .amdhsa_user_sgpr_kernarg_segment_ptr 1
  .amdhsa_system_sgpr_workgroup_id_x 1
  .amdhsa_float_denorm_mode_32 3
.end_amdhsa_kernel
```
